```python
import torch

def _softmax(x, axis=-1):
    return torch.softmax(x, dim=axis)
def _gelu(x):
    return torch.nn.functional.gelu(x, approximate="tanh")
def _silu(x):
    return torch.nn.functional.silu(x)
def _sigmoid(x):
    return torch.sigmoid(x)
def _layernorm(x, axis=-1, eps=1e-5):
    m = x.mean(dim=axis, keepdim=True)
    v = x.var(dim=axis, keepdim=True, unbiased=False)
    return (x - m) / torch.sqrt(v + eps)
def _scatter_add(tgt, idx, src, axis=0):
    return tgt.clone().index_add_(axis, idx, src)
def _segment_sum(src, seg, n):
    out = torch.zeros((n,) + src.shape[1:], dtype=src.dtype)
    return out.index_add_(0, seg, src)
def _pad(x, pw):
    flat = tuple(v for pair in reversed(pw) for v in pair)
    return torch.nn.functional.pad(x, flat)

kernel_name = 'concat_heads__gqa_block_cached__mha_block_cached__near_ridge'

def setup_inputs():

    _w = (lambda a: (lambda t: t.to(torch.bfloat16) if t.is_floating_point() else t)(torch.as_tensor(a)))
    def _A_setup():
        B, Sq, D = 8, 96, 640
        Hq, Hkv, Sk, Dh = 32, 32, 96, 128
        assert Hq % Hkv == 0, (Hq, Hkv)
        return {
            "x": _w((lambda *s: torch.randn(*s, dtype=torch.bfloat16) * 0.8)(B, Sq, D)),
            "k_cache": _w((lambda *s: torch.randn(*s, dtype=torch.bfloat16) * 0.8)(B, Hkv, Sk, Dh)),
            "v_cache": _w((lambda *s: torch.randn(*s, dtype=torch.bfloat16) * 0.05)(B, Hkv, Sk, Dh)),
            "wq": _w((lambda *s: torch.randn(*s, dtype=torch.bfloat16) * 0.8)(D, Hq * Dh) * (D ** -0.5)),
            "wo": _w((lambda *s: torch.randn(*s, dtype=torch.bfloat16) * 0.05)(Hq * Dh, D) * ((Hq * Dh) ** -0.5)),
        }
    _A_in = _A_setup()

    def _B_setup():
        B, Sq, D = 8, 96, 640
        H, Sk, Dh = 32, 96, 128
        return {
            "x": _w((lambda *s: torch.randn(*s, dtype=torch.bfloat16) * 0.8)(B, Sq, D)),
            "k_cache": _w((lambda *s: torch.randn(*s, dtype=torch.bfloat16) * 0.8)(B, H, Sk, Dh)),
            "v_cache": _w((lambda *s: torch.randn(*s, dtype=torch.bfloat16) * 0.05)(B, H, Sk, Dh)),
            "wq": _w((lambda *s: torch.randn(*s, dtype=torch.bfloat16) * 0.8)(D, H * Dh) * (D ** -0.5)),
            "wo": _w((lambda *s: torch.randn(*s, dtype=torch.bfloat16) * 0.05)(H * Dh, D) * ((H * Dh) ** -0.5)),
        }
    _B_in = _B_setup()

    return {
        "A_x": _A_in["x"],
        "A_k_cache": _A_in["k_cache"],
        "A_v_cache": _A_in["v_cache"],
        "A_wq": _A_in["wq"],
        "A_wo": _A_in["wo"],
        "B_x": _B_in["x"],
        "B_k_cache": _B_in["k_cache"],
        "B_v_cache": _B_in["v_cache"],
        "B_wq": _B_in["wq"],
        "B_wo": _B_in["wo"],
    }

def reference(A_x, A_k_cache, A_v_cache, A_wq, A_wo, B_x, B_k_cache, B_v_cache, B_wq, B_wo):
    def _A_ref(x, k_cache, v_cache, wq, wo):
        B, Sq, D = x.shape
        Hq, Dh = 32, 128
        Hkv = k_cache.shape[1]
        rep = Hq // Hkv
        q = (lambda x, *d: x.permute(*d))((x @ wq).reshape(B, Sq, Hq, Dh), 0, 2, 1, 3)
        k = (lambda x, n, axis: torch.repeat_interleave(x, n, dim=axis))(k_cache, rep, axis=1)
        v = (lambda x, n, axis: torch.repeat_interleave(x, n, dim=axis))(v_cache, rep, axis=1)
        scores = torch.einsum("bhqd,bhkd->bhqk", q, k) * (Dh ** -0.5)
        p = _softmax(scores, axis=-1)
        o = torch.einsum("bhqk,bhkd->bhqd", p, v)
        return (lambda x, *d: x.permute(*d))(o, 0, 2, 1, 3).reshape(B, Sq, Hq * Dh) @ wo

    def _B_ref(x, k_cache, v_cache, wq, wo):
        B, Sq, D = x.shape
        H, Dh = 32, 128
        q = (lambda x, *d: x.permute(*d))((x @ wq).reshape(B, Sq, H, Dh), 0, 2, 1, 3)
        scores = torch.einsum("bhqd,bhkd->bhqk", q, k_cache) * (Dh ** -0.5)
        p = _softmax(scores, axis=-1)
        o = torch.einsum("bhqk,bhkd->bhqd", p, v_cache)
        return (lambda x, *d: x.permute(*d))(o, 0, 2, 1, 3).reshape(B, Sq, H * Dh) @ wo

    a = _A_ref(A_x, A_k_cache, A_v_cache, A_wq, A_wo)
    b = _B_ref(B_x, B_k_cache, B_v_cache, B_wq, B_wo)
    return torch.concatenate([a, b], axis=-1)
```

```asm
; @launch grid=(256,1,1) block=(512,1,1) lds=163840
.amdgcn_target "amdgcn-amd-amdhsa--gfx950"
.text
.globl concat_heads__gqa_block_cached__mha_block_cached__near_ridge_kernel
.p2align 8
.type concat_heads__gqa_block_cached__mha_block_cached__near_ridge_kernel,@function
concat_heads__gqa_block_cached__mha_block_cached__near_ridge_kernel:
    s_load_dwordx16 s[8:23], s[0:1], 0
    s_load_dwordx8 s[24:31], s[0:1], 64
    s_load_dwordx2 s[56:57], s[0:1], 96
    s_cmp_ge_u32 s2, 256
    s_cbranch_scc1 L_end
    v_lshrrev_b32 v3, 6, v0
    v_and_b32 v0, 63, v0
    v_readfirstlane_b32 s36, v3
    s_and_b32 s3, s2, 7
    s_lshr_b32 s4, s2, 3
    s_lshr_b32 s5, s3, 2
    s_and_b32 s38, s3, 3
    s_lshl_b32 s6, s38, 3
    s_and_b32 s39, s4, 7
    s_add_u32 s6, s6, s39
    s_lshr_b32 s7, s4, 3
    v_lshrrev_b32 v3, 4, v0
    v_and_b32 v4, 15, v0
    s_and_b32 s37, s36, 3
    s_lshl_b32 s72, s7, 2
    s_add_u32 s72, s72, s37
    s_cmp_lt_u32 s36, 4
    s_cbranch_scc1 L_loader
    s_getpc_b64 s[34:35]
L_pc:
    s_lshl_b32 s73, s39, 2
    s_add_u32 s73, s73, s37
    s_lshl_b32 s73, s73, 10
    v_and_b32 v5, 7, v0
    v_lshl_add_u32 v5, v5, 7, s73
    v_min_u32 v5, L_end-L_pc, v5
    global_load_dword v2, v5, s[34:35]
    s_branch L_compute
L_loader:
    s_lshl_b32 s75, s37, 4
    v_add_u32 v5, s75, v3
    v_lshlrev_b32 v5, 13, v5
    v_lshlrev_b32 v6, 1, v3
    v_xor_b32 v6, v6, v4
    v_lshl_add_u32 v8, v6, 4, v5
    v_add_u32 v9, 31744, v8
    v_xor_b32 v6, 128, v8
    v_add_u32 v10, 63488, v6
    v_add_u32 v11, 95232, v6
    v_lshrrev_b32 v5, 3, v0
    v_and_b32 v6, 7, v0
    v_xor_b32 v6, v6, v3
    v_mul_u32_u24 v5, 1280, v5
    v_lshl_add_u32 v12, v6, 4, v5
    v_xor_b32 v6, 64, v12
    v_add_u32 v13, 9216, v6
    v_add_u32 v14, 18432, v12
    v_add_u32 v15, 30720, v6
    v_add_u32 v16, 39936, v12
    v_add_u32 v17, 49152, v6
    s_mul_i32 s76, s72, 61440
    s_lshl_b32 s77, s6, 8
    s_lshl_b32 s78, s37, 12
    s_mul_i32 s79, s37, 6144
    s_add_u32 s79, s79, 90112
    s_sub_u32 s100, s7, s39
    s_bfe_u32 s92, s100, 0x10001
    s_and_b32 s100, s100, 3
    s_mul_i32 s93, s92, 1
    s_mov_b32 s54, 5242880
    s_mov_b32 s55, 0x20000
    s_mov_b32 s42, 983040
    s_mov_b32 s43, 0x20000
    s_mov_b32 s80, 0
    s_mov_b32 s81, 0
    s_lshl_b32 s82, s93, 19
    s_add_u32 s82, s82, s77
    s_mov_b32 s84, s78
    s_waitcnt lgkmcnt(0)
    s_cmp_eq_u32 s5, 0
    s_cselect_b64 s[52:53], s[14:15], s[24:25]
    s_cselect_b64 s[40:41], s[8:9], s[18:19]
    s_mov_b32 m0, s84
    s_mov_b32 s86, s93
    buffer_load_dwordx4 v8, s[52:55], s82 offen offset:0  lds
    s_lshl_b32 s83, s86, 7
    s_add_u32 s83, s83, s76
    buffer_load_dwordx4 v9, s[52:55], s82 offen offset:1024  lds
    s_mul_i32 s85, s81, 24576
    s_add_u32 s85, s85, s79
    buffer_load_dwordx4 v10, s[52:55], s82 offen offset:2048  lds
    s_add_u32 s80, s80, 1
    s_add_u32 s81, s81, 1
    s_cmp_eq_u32 s81, 3
    s_cselect_b32 s81, 0, s81
    buffer_load_dwordx4 v11, s[52:55], s82 offen offset:3072  lds
    s_mov_b32 m0, s85
    s_mul_i32 s86, s92, -1
    s_add_u32 s86, s86, 1
    s_mov_b32 s58, 268435456
    s_mov_b32 s59, 0x20000
    s_lshl_b32 s32, s5, 5
    s_add_u32 s32, s32, s4
    s_lshl_b32 s32, s32, 2
    s_add_u32 s32, s32, s37
    s_lshl_b32 s32, s32, 2
    s_mul_i32 s34, s32, 128
    s_lshr_b32 s33, s34, 13
    s_lshl_b32 s33, s33, 13
    s_add_u32 s34, s34, s33
    s_add_u32 s34, s34, 51380224
    s_mul_i32 s33, s38, 32
    s_add_u32 s33, s33, s34
    s_lshl_b32 s35, s3, 14
    s_add_u32 s35, s35, 50331648
    s_mul_i32 s96, s4, 32
    s_add_u32 s96, s96, s35
    s_lshr_b32 s101, s2, 6
    s_lshl_b32 s101, s101, 6
    s_add_u32 s101, s101, s2
    s_lshl_b32 s101, s101, 7
    s_add_u32 s101, s101, 50855936
    s_bfe_u32 s70, s4, 0x10002
    s_lshl_b32 s70, s70, 13
    s_add_u32 s101, s101, s70
    s_mul_i32 s70, s38, 128
    s_add_u32 s70, s70, s34
    v_and_b32 v5, 7, v0
    v_mul_u32_u24 v21, 32, v5
    v_add_u32 v21, s70, v21
    v_writelane_b32 v21, s96, 4
    v_writelane_b32 v21, s96, 12
    v_writelane_b32 v21, s101, 5
    v_and_b32 v5, 8, v0
    v_lshl_add_u32 v21, v5, 10, v21
    v_mov_b32 v20, 0
    s_cmp_eq_u32 s37, 0
    s_cselect_b32 s70, 0x1030, 0
    s_or_b32 s70, s70, 0x0f0f
    s_mov_b32 s71, 0
    s_mov_b64 exec, s[70:71]
    buffer_store_dword v20, v21, s[56:59], 0 offen sc1
    s_mov_b64 exec, -1
    buffer_load_dwordx4 v12, s[40:43], s83 offen offset:0  lds
    s_lshl_b32 s82, s86, 19
    s_add_u32 s82, s82, s77
    buffer_load_dwordx4 v13, s[40:43], s83 offen offset:1024  lds
    s_lshl_b32 s84, s81, 14
    buffer_load_dwordx4 v14, s[40:43], s83 offen offset:2048  lds
    s_add_u32 m0, s85, 3072
    s_add_u32 s84, s84, s78
    buffer_load_dwordx4 v15, s[40:43], s83 offen offset:0  lds
    buffer_load_dwordx4 v16, s[40:43], s83 offen offset:1024  lds
    buffer_load_dwordx4 v17, s[40:43], s83 offen offset:2048  lds
    s_cmp_eq_u32 s5, 0
    s_cselect_b64 s[44:45], s[10:11], s[20:21]
    s_cselect_b64 s[48:49], s[12:13], s[22:23]
    s_cselect_b64 s[60:61], s[16:17], s[26:27]
    s_mov_b32 s46, 6291456
    s_mov_b32 s47, 0x20000
    s_mov_b32 s50, 6291456
    s_mov_b32 s51, 0x20000
    s_mov_b32 s62, 5242880
    s_mov_b32 s63, 0x20000
    s_mov_b32 s64, s30
    s_mov_b32 s65, s31
    s_mov_b32 s66, 256
    s_mov_b32 s67, 0x20000
    s_mul_i32 s73, s4, 52
    s_lshr_b32 s73, s73, 8
    s_mul_i32 s74, s73, 5
    s_sub_u32 s74, s4, s74
    v_lshlrev_b32 v22, 4, v0
    s_lshr_b32 s8, s72, 1
    s_lshl_b32 s8, s8, 5
    s_add_u32 s8, s8, s6
    s_mul_i32 s8, s8, 24576
    s_and_b32 s10, s37, 1
    s_lshl_b32 s86, s10, 11
    s_add_u32 s8, s8, s86
    v_xor_b32 v5, v3, v4
    v_lshlrev_b32 v5, 4, v5
    v_lshl_add_u32 v5, v3, 8, v5
    s_lshl_b32 s86, s10, 7
    v_xor_b32 v18, s86, v5
    v_xor_b32 v19, 64, v18
    s_lshl_b32 s9, s37, 11
    s_add_u32 s9, s9, 24576
    s_lshl_b32 s87, s7, 6
    s_add_u32 s87, s87, s6
    s_mul_i32 s87, s87, 24576
    s_mul_i32 s86, s37, 6144
    s_add_u32 s87, s87, s86
    v_lshlrev_b32 v5, 1, v3
    v_xor_b32 v5, v5, v4
    v_lshlrev_b32 v5, 4, v5
    v_lshl_add_u32 v23, v3, 8, v5
    v_xor_b32 v24, 128, v23
    s_mov_b32 s68, 2271560481
    s_mov_b32 s69, 9
    s_cmp_eq_u32 s100, 2
    s_cselect_b32 s68, 1770279472, s68
    s_cselect_b32 s69, 7, s69
    s_cmp_eq_u32 s100, 3
    s_cselect_b32 s68, 1770279472, s68
    s_cselect_b32 s69, 7, s69
    s_lshl_b32 s86, s100, 2
    s_lshr_b32 s11, 16979, s86
    s_and_b32 s11, s11, 15
    v_mov_b32 v6, 1
    s_lshl_b32 s12, s3, 5
    v_and_b32 v30, 7, v0
    v_lshlrev_b32 v30, 5, v30
    s_branch L_chunk
L_next:
    s_waitcnt vmcnt(10)
    s_barrier
L_chunk:
    s_mov_b32 m0, s84
    s_and_b32 s86, s68, 15
    buffer_load_dwordx4 v8, s[52:55], s82 offen offset:0  lds
    s_lshl_b32 s83, s86, 7
    s_add_u32 s83, s83, s76
    buffer_load_dwordx4 v9, s[52:55], s82 offen offset:1024  lds
    s_mul_i32 s85, s81, 24576
    s_add_u32 s85, s85, s79
    buffer_load_dwordx4 v10, s[52:55], s82 offen offset:2048  lds
    s_add_u32 s80, s80, 1
    s_add_u32 s81, s81, 1
    s_cmp_eq_u32 s81, 3
    s_cselect_b32 s81, 0, s81
    buffer_load_dwordx4 v11, s[52:55], s82 offen offset:3072  lds
    s_mov_b32 m0, s85
    s_lshr_b64 s[68:69], s[68:69], 4
    s_and_b32 s86, s68, 15
    buffer_load_dwordx4 v12, s[40:43], s83 offen offset:0  lds
    s_lshl_b32 s82, s86, 19
    s_add_u32 s82, s82, s77
    buffer_load_dwordx4 v13, s[40:43], s83 offen offset:1024  lds
    s_lshl_b32 s84, s81, 14
    buffer_load_dwordx4 v14, s[40:43], s83 offen offset:2048  lds
    s_add_u32 m0, s85, 3072
    s_add_u32 s84, s84, s78
    buffer_load_dwordx4 v15, s[40:43], s83 offen offset:0  lds
    buffer_load_dwordx4 v16, s[40:43], s83 offen offset:1024  lds
    buffer_load_dwordx4 v17, s[40:43], s83 offen offset:2048  lds
    s_cmp_eq_u32 s80, s11
    s_cbranch_scc1 L_kburst
    s_cmp_lt_u32 s80, 10
    s_cbranch_scc1 L_next
    s_waitcnt vmcnt(10)
    s_barrier
    buffer_load_dword v31, v30, s[64:67], 0 offen sc1
    s_add_u32 m0, s79, 24576
    s_add_u32 s86, s87, 0
    buffer_load_dwordx4 v23, s[48:51], s86 offen offset:0 nt lds
    buffer_load_dwordx4 v24, s[48:51], s86 offen offset:1024 nt lds
    buffer_load_dwordx4 v23, s[48:51], s86 offen offset:2048 nt lds
    buffer_load_dwordx4 v24, s[48:51], s86 offen offset:3072 nt lds
    s_add_u32 m0, s79, 28672
    s_add_u32 s86, s87, 4096
    buffer_load_dwordx4 v23, s[48:51], s86 offen offset:0 nt lds
    buffer_load_dwordx4 v24, s[48:51], s86 offen offset:1024 nt lds
    s_getpc_b64 s[20:21]
L_pc2:
    s_lshl_b32 s86, s39, 2
    s_add_u32 s86, s86, s37
    s_lshl_b32 s86, s86, 10
    v_and_b32 v44, 7, v0
    v_lshl_add_u32 v44, v44, 7, s86
    v_min_u32 v44, L_end-L_pc2, v44
    global_load_dword v45, v44, s[20:21]
    v_add_u32 v5, s9, v22
    ds_write_b128 v5, v[32:35] offset:0
    ds_write_b128 v5, v[36:39] offset:1024
    v_add_u32 v5, s75, v3
    v_mul_u32_u24 v5, 1280, v5
    v_or_b32 v7, 0, v3
    v_lshlrev_b32 v7, 1, v7
    v_xor_b32 v7, v7, v4
    v_lshl_add_u32 v7, v7, 4, v5
    v_add_u32 v25, 0, v7
    v_or_b32 v7, 4, v3
    v_lshlrev_b32 v7, 1, v7
    v_xor_b32 v7, v7, v4
    v_lshl_add_u32 v7, v7, 4, v5
    v_add_u32 v26, 4096, v7
    v_or_b32 v7, 0, v3
    v_lshlrev_b32 v7, 1, v7
    v_xor_b32 v7, v7, v4
    v_lshl_add_u32 v7, v7, 4, v5
    v_add_u32 v27, 8192, v7
    v_or_b32 v7, 4, v3
    v_lshlrev_b32 v7, 1, v7
    v_xor_b32 v7, v7, v4
    v_lshl_add_u32 v7, v7, 4, v5
    v_add_u32 v28, 12288, v7
    s_waitcnt vmcnt(8) lgkmcnt(0)
    s_barrier
    s_add_u32 m0, s79, 49152
    s_add_u32 s86, s87, 786432
    buffer_load_dwordx4 v23, s[48:51], s86 offen offset:0 nt lds
    buffer_load_dwordx4 v24, s[48:51], s86 offen offset:1024 nt lds
    buffer_load_dwordx4 v23, s[48:51], s86 offen offset:2048 nt lds
    buffer_load_dwordx4 v24, s[48:51], s86 offen offset:3072 nt lds
    s_mul_i32 s88, s38, 1310720
    s_lshl_b32 s86, s74, 8
    s_add_u32 s88, s88, s86
    s_lshl_b32 s89, s3, 22
    s_lshr_b32 s86, s37, 1
    s_mul_i32 s86, s86, 6
    s_add_u32 s86, s86, s73
    s_lshl_b32 s86, s86, 14
    s_add_u32 s89, s89, s86
    s_lshl_b32 s86, s10, 12
    s_add_u32 s89, s89, s86
    s_mul_i32 s90, s73, 171
    s_bfe_u32 s90, s90, 0x40006
    s_mov_b32 s91, s90
    s_mov_b32 s14, 625152098
    s_mov_b32 s15, 1649684742
    s_mov_b32 s16, 2274916743
    s_mov_b32 s17, 2038929529
    s_mov_b32 s92, 262144
L_cnt:
    s_waitcnt vmcnt(11)
    v_and_b32 v7, 0x3ff, v31
    v_cmp_gt_u32 vcc, 32, v7
    s_sub_u32 s92, s92, 1
    s_cbranch_scc1 L_cnt_ok
    s_nop 1
    s_cbranch_vccz L_cnt_ok
    buffer_load_dword v31, v30, s[64:67], 0 offen sc1
    s_waitcnt vmcnt(0)
    s_branch L_cnt
L_cnt_ok:
    v_bfe_u32 v5, v31, 10, 10
    v_lshlrev_b32 v5, 1, v5
    v_cmp_gt_u32 vcc, v5, v7
    v_ashrrev_i32 v7, 20, v31
    s_nop 0
    v_readlane_b32 s86, v7, 0
    v_readlane_b32 s13, v7, 1
    s_nop 1
    s_add_u32 s86, s86, s13
    v_readlane_b32 s13, v7, 2
    s_nop 1
    s_add_u32 s86, s86, s13
    v_readlane_b32 s13, v7, 3
    s_nop 1
    s_add_u32 s86, s86, s13
    v_readlane_b32 s13, v7, 4
    s_nop 1
    s_add_u32 s86, s86, s13
    v_readlane_b32 s13, v7, 5
    s_nop 1
    s_add_u32 s86, s86, s13
    v_readlane_b32 s13, v7, 6
    s_nop 1
    s_add_u32 s86, s86, s13
    v_readlane_b32 s13, v7, 7
    s_nop 1
    s_add_u32 s86, s86, s13
    s_cmp_gt_i32 s86, 0
    s_cselect_b32 s13, 0xff, 0
    s_xor_b32 s13, s13, vcc_lo
    s_and_b32 s13, s13, 0xff
    s_lshr_b32 s101, s13, s3
    s_and_b32 s101, s101, 1
    s_lshl_b32 s101, s101, 13
    s_add_u32 s89, s89, s101
    s_add_u32 s35, s35, s101
    s_add_u32 s96, s96, s101
    s_or_b32 s13, s13, s101
    v_mov_b32 v7, s13
    ds_write_b32 v20, v7 offset:16384
    s_waitcnt lgkmcnt(0)
    s_barrier
    s_add_u32 m0, s79, 53248
    s_add_u32 s86, s87, 790528
    buffer_load_dwordx4 v23, s[48:51], s86 offen offset:0 nt lds
    buffer_load_dwordx4 v24, s[48:51], s86 offen offset:1024 nt lds
    global_load_dword v45, v44, s[20:21]
    s_and_b32 s84, s14, 15
    s_lshr_b64 s[14:15], s[14:15], 4
    s_lshl_b32 s84, s84, 14
    s_add_u32 s84, s84, s78
    s_mul_i32 s82, s90, 81920
    s_add_u32 s82, s82, s88
    s_add_u32 s90, s90, 1
    s_and_b32 s90, s90, 15
    s_mov_b32 m0, s84
    s_nop 0
    buffer_load_dwordx4 v25, s[60:63], s82 offen offset:0 lds
    buffer_load_dwordx4 v26, s[60:63], s82 offen offset:1024 lds
    buffer_load_dwordx4 v27, s[60:63], s82 offen offset:2048 lds
    buffer_load_dwordx4 v28, s[60:63], s82 offen offset:3072 lds
    s_and_b32 s84, s14, 15
    s_lshr_b64 s[14:15], s[14:15], 4
    s_lshl_b32 s84, s84, 14
    s_add_u32 s84, s84, s78
    s_mul_i32 s82, s90, 81920
    s_add_u32 s82, s82, s88
    s_add_u32 s90, s90, 1
    s_and_b32 s90, s90, 15
    s_mov_b32 m0, s84
    s_nop 0
    buffer_load_dwordx4 v25, s[60:63], s82 offen offset:0 lds
    buffer_load_dwordx4 v26, s[60:63], s82 offen offset:1024 lds
    buffer_load_dwordx4 v27, s[60:63], s82 offen offset:2048 lds
    s_waitcnt vmcnt(8)
    s_barrier
    s_lshl_b32 s86, s73, 3
    s_mul_i32 s87, s86, 43
    s_lshr_b32 s87, s87, 9
    s_add_u32 s86, s86, 7
    s_mul_i32 s86, s86, 43
    s_lshr_b32 s86, s86, 9
    v_bfe_u32 v5, v0, 3, 1
    v_add_u32 v5, s87, v5
    v_min_u32 v5, s86, v5
    v_and_b32 v7, 7, v0
    v_lshl_add_u32 v5, v5, 3, v7
    v_mul_u32_u24 v29, 32, v5
    v_cmp_ne_u32 s[24:25], s4, v5
    s_nop 1
    s_and_b64 s[24:25], s[24:25], 0xffff
    v_mov_b32 v7, 0
    v_mov_b32 v2, 0
    s_and_b32 s85, s16, 15
    s_lshr_b64 s[16:17], s[16:17], 4
    s_lshl_b32 s85, s85, 14
    s_add_u32 s85, s85, s78
    s_and_b32 s83, s91, 7
    s_mul_i32 s83, s83, 196608
    s_add_u32 s83, s83, s89
    s_lshr_b32 s13, s91, 3
    s_mul_i32 s13, s13, 2105344
    s_xor_b32 s83, s83, s13
    s_add_u32 s91, s91, 1
    s_and_b32 s91, s91, 15
    s_barrier
    s_mov_b32 m0, s84
    s_nop 0
    buffer_load_dwordx4 v28, s[60:63], s82 offen offset:3072 lds
    s_and_b32 s84, s14, 15
    s_lshr_b64 s[14:15], s[14:15], 4
    s_lshl_b32 s84, s84, 14
    s_add_u32 s84, s84, s78
    s_mul_i32 s82, s90, 81920
    s_add_u32 s82, s82, s88
    s_add_u32 s90, s90, 1
    s_and_b32 s90, s90, 15
    s_mov_b32 m0, s84
    s_nop 0
    buffer_load_dwordx4 v25, s[60:63], s82 offen offset:0 lds
    buffer_load_dwordx4 v26, s[60:63], s82 offen offset:1024 lds
    buffer_load_dwordx4 v27, s[60:63], s82 offen offset:2048 lds
    buffer_load_dwordx4 v28, s[60:63], s82 offen offset:3072 lds
    s_and_b32 s84, s14, 15
    s_lshr_b64 s[14:15], s[14:15], 4
    s_lshl_b32 s84, s84, 14
    s_add_u32 s84, s84, s78
    s_mul_i32 s82, s90, 81920
    s_add_u32 s82, s82, s88
    s_add_u32 s90, s90, 1
    s_and_b32 s90, s90, 15
    s_mov_b32 m0, s84
    s_nop 0
    buffer_load_dwordx4 v25, s[60:63], s82 offen offset:0 lds
    s_cmp_lg_u32 s37, 0
    s_barrier
    s_cbranch_scc1 L_noflag
    s_mov_b64 exec, 1
    buffer_store_dword v6, v20, s[56:59], s96 offen sc1
    s_mov_b64 exec, -1
L_noflag:
    s_cmp_ge_u32 s4, 30
    s_cbranch_scc1 L_ldone
    s_mov_b32 m0, s84
    s_nop 0
    buffer_load_dwordx4 v26, s[60:63], s82 offen offset:1024 lds
    buffer_load_dwordx4 v27, s[60:63], s82 offen offset:2048 lds
    buffer_load_dwordx4 v28, s[60:63], s82 offen offset:3072 lds
    s_and_b32 s84, s14, 15
    s_lshr_b64 s[14:15], s[14:15], 4
    s_lshl_b32 s84, s84, 14
    s_add_u32 s84, s84, s78
    s_mul_i32 s82, s90, 81920
    s_add_u32 s82, s82, s88
    s_add_u32 s90, s90, 1
    s_and_b32 s90, s90, 15
    s_mov_b32 m0, s84
    s_nop 0
    buffer_load_dwordx4 v25, s[60:63], s82 offen offset:0 lds
    buffer_load_dwordx4 v26, s[60:63], s82 offen offset:1024 lds
    buffer_load_dwordx4 v27, s[60:63], s82 offen offset:2048 lds
    buffer_load_dwordx4 v28, s[60:63], s82 offen offset:3072 lds
    s_and_b32 s84, s14, 15
    s_lshr_b64 s[14:15], s[14:15], 4
    s_lshl_b32 s84, s84, 14
    s_add_u32 s84, s84, s78
    s_mul_i32 s82, s90, 81920
    s_add_u32 s82, s82, s88
    s_add_u32 s90, s90, 1
    s_and_b32 s90, s90, 15
    s_mov_b32 m0, s84
    s_nop 0
    buffer_load_dwordx4 v25, s[60:63], s82 offen offset:0 lds
    buffer_load_dwordx4 v26, s[60:63], s82 offen offset:1024 lds
    buffer_load_dwordx4 v27, s[60:63], s82 offen offset:2048 lds
    buffer_load_dwordx4 v28, s[60:63], s82 offen offset:3072 lds
    s_cmp_lg_u32 s37, 0
    s_cbranch_scc1 L_nopoll
    s_mov_b64 exec, s[24:25]
    buffer_load_dword v7, v29, s[56:59], s35 offen sc1
    s_mov_b64 exec, -1
L_nopoll:
    s_and_b32 s84, s14, 15
    s_lshr_b64 s[14:15], s[14:15], 4
    s_lshl_b32 s84, s84, 14
    s_add_u32 s84, s84, s78
    s_mul_i32 s82, s90, 81920
    s_add_u32 s82, s82, s88
    s_add_u32 s90, s90, 1
    s_and_b32 s90, s90, 15
    s_cmp_lg_u32 s37, 0
    s_cbranch_scc1 L_seen
    s_mov_b64 exec, s[24:25]
    s_mov_b32 s92, 262144
L_f1:
    s_waitcnt vmcnt(0)
    v_cmp_ne_u32 vcc, 1, v7
    s_sub_u32 s92, s92, 1
    s_cbranch_scc1 L_f1_ok
    s_nop 1
    s_cbranch_vccz L_f1_ok
    buffer_load_dword v7, v29, s[56:59], s35 offen sc1
    s_waitcnt vmcnt(0)
    s_branch L_f1
L_f1_ok:
    s_mov_b64 exec, -1
L_seen:
    s_barrier
    s_mov_b32 m0, s85
    s_nop 0
    buffer_load_dwordx4 v22, s[56:59], s83 offen offset:0 sc1 lds
    buffer_load_dwordx4 v22, s[56:59], s83 offen offset:1024 sc1 lds
    buffer_load_dwordx4 v22, s[56:59], s83 offen offset:2048 sc1 lds
    buffer_load_dwordx4 v22, s[56:59], s83 offen offset:3072 sc1 lds
    s_and_b32 s85, s16, 15
    s_lshr_b64 s[16:17], s[16:17], 4
    s_lshl_b32 s85, s85, 14
    s_add_u32 s85, s85, s78
    s_and_b32 s83, s91, 7
    s_mul_i32 s83, s83, 196608
    s_add_u32 s83, s83, s89
    s_lshr_b32 s13, s91, 3
    s_mul_i32 s13, s13, 2105344
    s_xor_b32 s83, s83, s13
    s_add_u32 s91, s91, 1
    s_and_b32 s91, s91, 15
    s_mov_b32 m0, s85
    s_nop 0
    buffer_load_dwordx4 v22, s[56:59], s83 offen offset:0 sc1 lds
    buffer_load_dwordx4 v22, s[56:59], s83 offen offset:1024 sc1 lds
    buffer_load_dwordx4 v22, s[56:59], s83 offen offset:2048 sc1 lds
    buffer_load_dwordx4 v22, s[56:59], s83 offen offset:3072 sc1 lds
    s_and_b32 s85, s16, 15
    s_lshr_b64 s[16:17], s[16:17], 4
    s_lshl_b32 s85, s85, 14
    s_add_u32 s85, s85, s78
    s_and_b32 s83, s91, 7
    s_mul_i32 s83, s83, 196608
    s_add_u32 s83, s83, s89
    s_lshr_b32 s13, s91, 3
    s_mul_i32 s13, s13, 2105344
    s_xor_b32 s83, s83, s13
    s_add_u32 s91, s91, 1
    s_and_b32 s91, s91, 15
    s_mov_b32 m0, s84
    s_nop 0
    buffer_load_dwordx4 v25, s[60:63], s82 offen offset:0 lds
    buffer_load_dwordx4 v26, s[60:63], s82 offen offset:1024 lds
    buffer_load_dwordx4 v27, s[60:63], s82 offen offset:2048 lds
    s_waitcnt vmcnt(7)
    s_barrier
    s_mov_b32 m0, s85
    s_nop 0
    buffer_load_dwordx4 v22, s[56:59], s83 offen offset:0 sc1 lds
    buffer_load_dwordx4 v22, s[56:59], s83 offen offset:1024 sc1 lds
    buffer_load_dwordx4 v22, s[56:59], s83 offen offset:2048 sc1 lds
    buffer_load_dwordx4 v22, s[56:59], s83 offen offset:3072 sc1 lds
    s_and_b32 s85, s16, 15
    s_lshr_b64 s[16:17], s[16:17], 4
    s_lshl_b32 s85, s85, 14
    s_add_u32 s85, s85, s78
    s_and_b32 s83, s91, 7
    s_mul_i32 s83, s83, 196608
    s_add_u32 s83, s83, s89
    s_lshr_b32 s13, s91, 3
    s_mul_i32 s13, s13, 2105344
    s_xor_b32 s83, s83, s13
    s_add_u32 s91, s91, 1
    s_and_b32 s91, s91, 15
    s_mov_b32 m0, s84
    s_nop 0
    buffer_load_dwordx4 v28, s[60:63], s82 offen offset:3072 lds
    s_waitcnt vmcnt(8)
    s_barrier
    s_mov_b32 m0, s85
    s_nop 0
    buffer_load_dwordx4 v22, s[56:59], s83 offen offset:0 sc1 lds
    buffer_load_dwordx4 v22, s[56:59], s83 offen offset:1024 sc1 lds
    buffer_load_dwordx4 v22, s[56:59], s83 offen offset:2048 sc1 lds
    buffer_load_dwordx4 v22, s[56:59], s83 offen offset:3072 sc1 lds
    s_and_b32 s85, s16, 15
    s_lshr_b64 s[16:17], s[16:17], 4
    s_lshl_b32 s85, s85, 14
    s_add_u32 s85, s85, s78
    s_and_b32 s83, s91, 7
    s_mul_i32 s83, s83, 196608
    s_add_u32 s83, s83, s89
    s_lshr_b32 s13, s91, 3
    s_mul_i32 s13, s13, 2105344
    s_xor_b32 s83, s83, s13
    s_add_u32 s91, s91, 1
    s_and_b32 s91, s91, 15
    s_and_b32 s84, s14, 15
    s_lshr_b64 s[14:15], s[14:15], 4
    s_lshl_b32 s84, s84, 14
    s_add_u32 s84, s84, s78
    s_mul_i32 s82, s90, 81920
    s_add_u32 s82, s82, s88
    s_add_u32 s90, s90, 1
    s_and_b32 s90, s90, 15
    s_mov_b32 m0, s84
    s_nop 0
    buffer_load_dwordx4 v25, s[60:63], s82 offen offset:0 lds
    buffer_load_dwordx4 v26, s[60:63], s82 offen offset:1024 lds
    buffer_load_dwordx4 v27, s[60:63], s82 offen offset:2048 lds
    s_waitcnt vmcnt(8)
    s_barrier
    s_mov_b32 m0, s85
    s_nop 0
    buffer_load_dwordx4 v22, s[56:59], s83 offen offset:0 sc1 lds
    buffer_load_dwordx4 v22, s[56:59], s83 offen offset:1024 sc1 lds
    buffer_load_dwordx4 v22, s[56:59], s83 offen offset:2048 sc1 lds
    buffer_load_dwordx4 v22, s[56:59], s83 offen offset:3072 sc1 lds
    s_and_b32 s85, s16, 15
    s_lshr_b64 s[16:17], s[16:17], 4
    s_lshl_b32 s85, s85, 14
    s_add_u32 s85, s85, s78
    s_and_b32 s83, s91, 7
    s_mul_i32 s83, s83, 196608
    s_add_u32 s83, s83, s89
    s_lshr_b32 s13, s91, 3
    s_mul_i32 s13, s13, 2105344
    s_xor_b32 s83, s83, s13
    s_add_u32 s91, s91, 1
    s_and_b32 s91, s91, 15
    s_mov_b32 m0, s84
    s_nop 0
    buffer_load_dwordx4 v28, s[60:63], s82 offen offset:3072 lds
    s_and_b32 s84, s14, 15
    s_lshr_b64 s[14:15], s[14:15], 4
    s_lshl_b32 s84, s84, 14
    s_add_u32 s84, s84, s78
    s_mul_i32 s82, s90, 81920
    s_add_u32 s82, s82, s88
    s_add_u32 s90, s90, 1
    s_and_b32 s90, s90, 15
    s_mov_b32 m0, s84
    s_nop 0
    buffer_load_dwordx4 v25, s[60:63], s82 offen offset:0 lds
    buffer_load_dwordx4 v26, s[60:63], s82 offen offset:1024 lds
    s_waitcnt vmcnt(10)
    s_barrier
    s_mov_b32 m0, s85
    s_nop 0
    buffer_load_dwordx4 v22, s[56:59], s83 offen offset:0 sc1 lds
    buffer_load_dwordx4 v22, s[56:59], s83 offen offset:1024 sc1 lds
    buffer_load_dwordx4 v22, s[56:59], s83 offen offset:2048 sc1 lds
    buffer_load_dwordx4 v22, s[56:59], s83 offen offset:3072 sc1 lds
    s_and_b32 s85, s16, 15
    s_lshr_b64 s[16:17], s[16:17], 4
    s_lshl_b32 s85, s85, 14
    s_add_u32 s85, s85, s78
    s_and_b32 s83, s91, 7
    s_mul_i32 s83, s83, 196608
    s_add_u32 s83, s83, s89
    s_lshr_b32 s13, s91, 3
    s_mul_i32 s13, s13, 2105344
    s_xor_b32 s83, s83, s13
    s_add_u32 s91, s91, 1
    s_and_b32 s91, s91, 15
    s_mov_b32 m0, s84
    s_nop 0
    buffer_load_dwordx4 v27, s[60:63], s82 offen offset:2048 lds
    buffer_load_dwordx4 v28, s[60:63], s82 offen offset:3072 lds
    s_waitcnt vmcnt(9)
    s_barrier
    s_mov_b32 m0, s85
    s_nop 0
    buffer_load_dwordx4 v22, s[56:59], s83 offen offset:0 sc1 lds
    buffer_load_dwordx4 v22, s[56:59], s83 offen offset:1024 sc1 lds
    buffer_load_dwordx4 v22, s[56:59], s83 offen offset:2048 sc1 lds
    buffer_load_dwordx4 v22, s[56:59], s83 offen offset:3072 sc1 lds
    s_and_b32 s85, s16, 15
    s_lshr_b64 s[16:17], s[16:17], 4
    s_lshl_b32 s85, s85, 14
    s_add_u32 s85, s85, s78
    s_and_b32 s83, s91, 7
    s_mul_i32 s83, s83, 196608
    s_add_u32 s83, s83, s89
    s_lshr_b32 s13, s91, 3
    s_mul_i32 s13, s13, 2105344
    s_xor_b32 s83, s83, s13
    s_add_u32 s91, s91, 1
    s_and_b32 s91, s91, 15
    s_and_b32 s84, s14, 15
    s_lshr_b64 s[14:15], s[14:15], 4
    s_lshl_b32 s84, s84, 14
    s_add_u32 s84, s84, s78
    s_mul_i32 s82, s90, 81920
    s_add_u32 s82, s82, s88
    s_add_u32 s90, s90, 1
    s_and_b32 s90, s90, 15
    s_mov_b32 m0, s84
    s_nop 0
    buffer_load_dwordx4 v25, s[60:63], s82 offen offset:0 lds
    buffer_load_dwordx4 v26, s[60:63], s82 offen offset:1024 lds
    buffer_load_dwordx4 v27, s[60:63], s82 offen offset:2048 lds
    s_waitcnt vmcnt(9)
    s_barrier
    s_mov_b32 m0, s85
    s_nop 0
    buffer_load_dwordx4 v22, s[56:59], s83 offen offset:0 sc1 lds
    buffer_load_dwordx4 v22, s[56:59], s83 offen offset:1024 sc1 lds
    buffer_load_dwordx4 v22, s[56:59], s83 offen offset:2048 sc1 lds
    buffer_load_dwordx4 v22, s[56:59], s83 offen offset:3072 sc1 lds
    s_and_b32 s85, s16, 15
    s_lshr_b64 s[16:17], s[16:17], 4
    s_lshl_b32 s85, s85, 14
    s_add_u32 s85, s85, s78
    s_and_b32 s83, s91, 7
    s_mul_i32 s83, s83, 196608
    s_add_u32 s83, s83, s89
    s_lshr_b32 s13, s91, 3
    s_mul_i32 s13, s13, 2105344
    s_xor_b32 s83, s83, s13
    s_add_u32 s91, s91, 1
    s_and_b32 s91, s91, 15
    global_load_dword v45, v44, s[20:21]
    s_mov_b32 m0, s84
    s_nop 0
    buffer_load_dwordx4 v28, s[60:63], s82 offen offset:3072 lds
    s_and_b32 s84, s14, 15
    s_lshr_b64 s[14:15], s[14:15], 4
    s_lshl_b32 s84, s84, 14
    s_add_u32 s84, s84, s78
    s_mul_i32 s82, s90, 81920
    s_add_u32 s82, s82, s88
    s_add_u32 s90, s90, 1
    s_and_b32 s90, s90, 15
    s_mov_b32 m0, s84
    s_nop 0
    buffer_load_dwordx4 v25, s[60:63], s82 offen offset:0 lds
    buffer_load_dwordx4 v26, s[60:63], s82 offen offset:1024 lds
    s_waitcnt vmcnt(11)
    s_barrier
    s_mov_b32 m0, s85
    s_nop 0
    buffer_load_dwordx4 v22, s[56:59], s83 offen offset:0 sc1 lds
    buffer_load_dwordx4 v22, s[56:59], s83 offen offset:1024 sc1 lds
    buffer_load_dwordx4 v22, s[56:59], s83 offen offset:2048 sc1 lds
    buffer_load_dwordx4 v22, s[56:59], s83 offen offset:3072 sc1 lds
    s_and_b32 s85, s16, 15
    s_lshr_b64 s[16:17], s[16:17], 4
    s_lshl_b32 s85, s85, 14
    s_add_u32 s85, s85, s78
    s_and_b32 s83, s91, 7
    s_mul_i32 s83, s83, 196608
    s_add_u32 s83, s83, s89
    s_lshr_b32 s13, s91, 3
    s_mul_i32 s13, s13, 2105344
    s_xor_b32 s83, s83, s13
    s_add_u32 s91, s91, 1
    s_and_b32 s91, s91, 15
    s_mov_b32 m0, s84
    s_nop 0
    buffer_load_dwordx4 v27, s[60:63], s82 offen offset:2048 lds
    buffer_load_dwordx4 v28, s[60:63], s82 offen offset:3072 lds
    s_and_b32 s84, s14, 15
    s_lshr_b64 s[14:15], s[14:15], 4
    s_lshl_b32 s84, s84, 14
    s_add_u32 s84, s84, s78
    s_mul_i32 s82, s90, 81920
    s_add_u32 s82, s82, s88
    s_add_u32 s90, s90, 1
    s_and_b32 s90, s90, 15
    s_mov_b32 m0, s84
    s_nop 0
    buffer_load_dwordx4 v25, s[60:63], s82 offen offset:0 lds
    s_waitcnt vmcnt(11)
    s_barrier
    s_mov_b32 m0, s85
    s_nop 0
    buffer_load_dwordx4 v22, s[56:59], s83 offen offset:0 sc1 lds
    buffer_load_dwordx4 v22, s[56:59], s83 offen offset:1024 sc1 lds
    buffer_load_dwordx4 v22, s[56:59], s83 offen offset:2048 sc1 lds
    buffer_load_dwordx4 v22, s[56:59], s83 offen offset:3072 sc1 lds
    s_and_b32 s85, s16, 15
    s_lshr_b64 s[16:17], s[16:17], 4
    s_lshl_b32 s85, s85, 14
    s_add_u32 s85, s85, s78
    s_and_b32 s83, s91, 7
    s_mul_i32 s83, s83, 196608
    s_add_u32 s83, s83, s89
    s_lshr_b32 s13, s91, 3
    s_mul_i32 s13, s13, 2105344
    s_xor_b32 s83, s83, s13
    s_add_u32 s91, s91, 1
    s_and_b32 s91, s91, 15
    s_mov_b32 m0, s84
    s_nop 0
    buffer_load_dwordx4 v26, s[60:63], s82 offen offset:1024 lds
    buffer_load_dwordx4 v27, s[60:63], s82 offen offset:2048 lds
    s_waitcnt vmcnt(9)
    s_barrier
    s_mov_b32 m0, s85
    s_nop 0
    buffer_load_dwordx4 v22, s[56:59], s83 offen offset:0 sc1 lds
    buffer_load_dwordx4 v22, s[56:59], s83 offen offset:1024 sc1 lds
    buffer_load_dwordx4 v22, s[56:59], s83 offen offset:2048 sc1 lds
    buffer_load_dwordx4 v22, s[56:59], s83 offen offset:3072 sc1 lds
    s_and_b32 s85, s16, 15
    s_lshr_b64 s[16:17], s[16:17], 4
    s_lshl_b32 s85, s85, 14
    s_add_u32 s85, s85, s78
    s_and_b32 s83, s91, 7
    s_mul_i32 s83, s83, 196608
    s_add_u32 s83, s83, s89
    s_lshr_b32 s13, s91, 3
    s_mul_i32 s13, s13, 2105344
    s_xor_b32 s83, s83, s13
    s_add_u32 s91, s91, 1
    s_and_b32 s91, s91, 15
    s_mov_b32 m0, s84
    s_nop 0
    buffer_load_dwordx4 v28, s[60:63], s82 offen offset:3072 lds
    s_and_b32 s84, s14, 15
    s_lshr_b64 s[14:15], s[14:15], 4
    s_lshl_b32 s84, s84, 14
    s_add_u32 s84, s84, s78
    s_mul_i32 s82, s90, 81920
    s_add_u32 s82, s82, s88
    s_add_u32 s90, s90, 1
    s_and_b32 s90, s90, 15
    s_mov_b32 m0, s84
    s_nop 0
    buffer_load_dwordx4 v25, s[60:63], s82 offen offset:0 lds
    buffer_load_dwordx4 v26, s[60:63], s82 offen offset:1024 lds
    s_waitcnt vmcnt(9)
    s_barrier
    s_mov_b32 m0, s85
    s_nop 0
    buffer_load_dwordx4 v22, s[56:59], s83 offen offset:0 sc1 lds
    buffer_load_dwordx4 v22, s[56:59], s83 offen offset:1024 sc1 lds
    buffer_load_dwordx4 v22, s[56:59], s83 offen offset:2048 sc1 lds
    buffer_load_dwordx4 v22, s[56:59], s83 offen offset:3072 sc1 lds
    s_and_b32 s85, s16, 15
    s_lshr_b64 s[16:17], s[16:17], 4
    s_lshl_b32 s85, s85, 14
    s_add_u32 s85, s85, s78
    s_and_b32 s83, s91, 7
    s_mul_i32 s83, s83, 196608
    s_add_u32 s83, s83, s89
    s_lshr_b32 s13, s91, 3
    s_mul_i32 s13, s13, 2105344
    s_xor_b32 s83, s83, s13
    s_add_u32 s91, s91, 1
    s_and_b32 s91, s91, 15
    s_mov_b32 m0, s84
    s_nop 0
    buffer_load_dwordx4 v27, s[60:63], s82 offen offset:2048 lds
    buffer_load_dwordx4 v28, s[60:63], s82 offen offset:3072 lds
    s_and_b32 s84, s14, 15
    s_lshr_b64 s[14:15], s[14:15], 4
    s_lshl_b32 s84, s84, 14
    s_add_u32 s84, s84, s78
    s_mul_i32 s82, s90, 81920
    s_add_u32 s82, s82, s88
    s_add_u32 s90, s90, 1
    s_and_b32 s90, s90, 15
    s_mov_b32 m0, s84
    s_nop 0
    buffer_load_dwordx4 v25, s[60:63], s82 offen offset:0 lds
    s_waitcnt vmcnt(10)
    s_barrier
    s_mov_b32 m0, s85
    s_nop 0
    buffer_load_dwordx4 v22, s[56:59], s83 offen offset:0 sc1 lds
    buffer_load_dwordx4 v22, s[56:59], s83 offen offset:1024 sc1 lds
    buffer_load_dwordx4 v22, s[56:59], s83 offen offset:2048 sc1 lds
    buffer_load_dwordx4 v22, s[56:59], s83 offen offset:3072 sc1 lds
    s_and_b32 s85, s16, 15
    s_lshr_b64 s[16:17], s[16:17], 4
    s_lshl_b32 s85, s85, 14
    s_add_u32 s85, s85, s78
    s_and_b32 s83, s91, 7
    s_mul_i32 s83, s83, 196608
    s_add_u32 s83, s83, s89
    s_lshr_b32 s13, s91, 3
    s_mul_i32 s13, s13, 2105344
    s_xor_b32 s83, s83, s13
    s_add_u32 s91, s91, 1
    s_and_b32 s91, s91, 15
    s_mov_b32 m0, s84
    s_nop 0
    buffer_load_dwordx4 v26, s[60:63], s82 offen offset:1024 lds
    buffer_load_dwordx4 v27, s[60:63], s82 offen offset:2048 lds
    buffer_load_dwordx4 v28, s[60:63], s82 offen offset:3072 lds
    s_waitcnt vmcnt(10)
    s_barrier
    s_mov_b32 m0, s85
    s_nop 0
    buffer_load_dwordx4 v22, s[56:59], s83 offen offset:0 sc1 lds
    buffer_load_dwordx4 v22, s[56:59], s83 offen offset:1024 sc1 lds
    buffer_load_dwordx4 v22, s[56:59], s83 offen offset:2048 sc1 lds
    buffer_load_dwordx4 v22, s[56:59], s83 offen offset:3072 sc1 lds
    s_and_b32 s85, s16, 15
    s_lshr_b64 s[16:17], s[16:17], 4
    s_lshl_b32 s85, s85, 14
    s_add_u32 s85, s85, s78
    s_and_b32 s83, s91, 7
    s_mul_i32 s83, s83, 196608
    s_add_u32 s83, s83, s89
    s_lshr_b32 s13, s91, 3
    s_mul_i32 s13, s13, 2105344
    s_xor_b32 s83, s83, s13
    s_add_u32 s91, s91, 1
    s_and_b32 s91, s91, 15
    s_and_b32 s84, s14, 15
    s_lshr_b64 s[14:15], s[14:15], 4
    s_lshl_b32 s84, s84, 14
    s_add_u32 s84, s84, s78
    s_mul_i32 s82, s90, 81920
    s_add_u32 s82, s82, s88
    s_add_u32 s90, s90, 1
    s_and_b32 s90, s90, 15
    s_mov_b32 m0, s84
    s_nop 0
    buffer_load_dwordx4 v25, s[60:63], s82 offen offset:0 lds
    buffer_load_dwordx4 v26, s[60:63], s82 offen offset:1024 lds
    s_waitcnt vmcnt(9)
    s_barrier
    s_mov_b32 m0, s85
    s_nop 0
    buffer_load_dwordx4 v22, s[56:59], s83 offen offset:0 sc1 lds
    buffer_load_dwordx4 v22, s[56:59], s83 offen offset:1024 sc1 lds
    buffer_load_dwordx4 v22, s[56:59], s83 offen offset:2048 sc1 lds
    buffer_load_dwordx4 v22, s[56:59], s83 offen offset:3072 sc1 lds
    s_and_b32 s85, s16, 15
    s_lshr_b64 s[16:17], s[16:17], 4
    s_lshl_b32 s85, s85, 14
    s_add_u32 s85, s85, s78
    s_and_b32 s83, s91, 7
    s_mul_i32 s83, s83, 196608
    s_add_u32 s83, s83, s89
    s_lshr_b32 s13, s91, 3
    s_mul_i32 s13, s13, 2105344
    s_xor_b32 s83, s83, s13
    s_add_u32 s91, s91, 1
    s_and_b32 s91, s91, 15
    s_mov_b32 m0, s84
    s_nop 0
    buffer_load_dwordx4 v27, s[60:63], s82 offen offset:2048 lds
    buffer_load_dwordx4 v28, s[60:63], s82 offen offset:3072 lds
    s_and_b32 s84, s14, 15
    s_lshr_b64 s[14:15], s[14:15], 4
    s_lshl_b32 s84, s84, 14
    s_add_u32 s84, s84, s78
    s_mul_i32 s82, s90, 81920
    s_add_u32 s82, s82, s88
    s_add_u32 s90, s90, 1
    s_and_b32 s90, s90, 15
    s_mov_b32 m0, s84
    s_nop 0
    buffer_load_dwordx4 v25, s[60:63], s82 offen offset:0 lds
    s_waitcnt vmcnt(9)
    s_barrier
    s_mov_b32 m0, s85
    s_nop 0
    buffer_load_dwordx4 v22, s[56:59], s83 offen offset:0 sc1 lds
    buffer_load_dwordx4 v22, s[56:59], s83 offen offset:1024 sc1 lds
    buffer_load_dwordx4 v22, s[56:59], s83 offen offset:2048 sc1 lds
    buffer_load_dwordx4 v22, s[56:59], s83 offen offset:3072 sc1 lds
    s_mov_b32 m0, s84
    s_nop 0
    buffer_load_dwordx4 v26, s[60:63], s82 offen offset:1024 lds
    buffer_load_dwordx4 v27, s[60:63], s82 offen offset:2048 lds
    buffer_load_dwordx4 v28, s[60:63], s82 offen offset:3072 lds
    s_waitcnt vmcnt(8)
    s_barrier
    s_waitcnt vmcnt(0)
    s_barrier
L_ldone:
    s_endpgm
L_kburst:
    s_waitcnt vmcnt(10)
    s_barrier
    s_add_u32 m0, s9, 24576
    s_nop 0
    buffer_load_dwordx4 v18, s[44:47], s8 offen offset:0 nt lds
    s_cmp_lg_u32 s37, 0
    s_cbranch_scc1 L_np
    s_mov_b32 s16, 64
    s_mov_b32 s18, 0
    s_buffer_load_dword s16, s[56:59], s101 glc
L_probe:
    s_add_u32 s18, s18, 1
    s_and_b32 s17, s16, 64
    s_cmp_lt_u32 s18, s17
    s_cbranch_scc1 L_probe
    s_waitcnt lgkmcnt(0)
    s_getreg_b32 s14, hwreg(HW_REG_XCC_ID, 2, 1)
    s_bfe_u32 s13, s4, 0x10002
    s_sub_u32 s18, s18, 16
    s_sub_u32 s17, 0, s18
    s_cmp_eq_u32 s13, s14
    s_cselect_b32 s18, s18, s17
    s_lshl_b32 s18, s18, 20
    s_lshl_b32 s14, s14, 10
    s_add_u32 s18, s18, s14
    s_add_u32 s18, s18, 1
    v_mov_b32 v7, s18
    s_mov_b64 exec, 1
    buffer_atomic_add v7, v20, s[64:67], s12 offen sc1
    s_mov_b64 exec, -1
L_np:
    buffer_load_dwordx4 v19, s[44:47], s8 offen offset:1024 nt lds
    s_add_u32 s8, s8, 4096
    s_add_u32 m0, s9, 32768
    s_nop 0
    buffer_load_dwordx4 v18, s[44:47], s8 offen offset:0 nt lds
    buffer_load_dwordx4 v19, s[44:47], s8 offen offset:1024 nt lds
    s_add_u32 s8, s8, 4096
    s_add_u32 m0, s9, 40960
    s_nop 0
    buffer_load_dwordx4 v18, s[44:47], s8 offen offset:0 nt lds
    buffer_load_dwordx4 v19, s[44:47], s8 offen offset:1024 nt lds
    s_add_u32 s8, s8, 4096
    s_add_u32 m0, s9, 49152
    s_nop 0
    buffer_load_dwordx4 v18, s[44:47], s8 offen offset:0 nt lds
    buffer_load_dwordx4 v19, s[44:47], s8 offen offset:1024 nt lds
    s_add_u32 s8, s8, 4096
    s_add_u32 m0, s9, 57344
    s_nop 0
    buffer_load_dwordx4 v18, s[44:47], s8 offen offset:0 nt lds
    buffer_load_dwordx4 v19, s[44:47], s8 offen offset:1024 nt lds
    s_add_u32 s8, s8, 4096
    buffer_load_dwordx4 v[32:35], v18, s[44:47], s8 offen offset:0 nt
    buffer_load_dwordx4 v[36:39], v19, s[44:47], s8 offen offset:1024 nt
    s_mov_b32 s11, 0
    s_cmp_lg_u32 s37, 0
    s_cbranch_scc1 L_kw
    s_waitcnt vmcnt(13)
    s_branch L_kb
L_kw:
    s_waitcnt vmcnt(12)
L_kb:
    s_barrier
    s_mov_b32 m0, s84
    s_and_b32 s86, s68, 15
    buffer_load_dwordx4 v8, s[52:55], s82 offen offset:0  lds
    s_lshl_b32 s83, s86, 7
    s_add_u32 s83, s83, s76
    buffer_load_dwordx4 v9, s[52:55], s82 offen offset:1024  lds
    s_mul_i32 s85, s81, 24576
    s_add_u32 s85, s85, s79
    buffer_load_dwordx4 v10, s[52:55], s82 offen offset:2048  lds
    s_add_u32 s80, s80, 1
    s_add_u32 s81, s81, 1
    s_cmp_eq_u32 s81, 3
    s_cselect_b32 s81, 0, s81
    buffer_load_dwordx4 v11, s[52:55], s82 offen offset:3072  lds
    s_mov_b32 m0, s85
    s_lshr_b64 s[68:69], s[68:69], 4
    s_and_b32 s86, s68, 15
    buffer_load_dwordx4 v12, s[40:43], s83 offen offset:0  lds
    s_lshl_b32 s82, s86, 19
    s_add_u32 s82, s82, s77
    buffer_load_dwordx4 v13, s[40:43], s83 offen offset:1024  lds
    s_lshl_b32 s84, s81, 14
    buffer_load_dwordx4 v14, s[40:43], s83 offen offset:2048  lds
    s_add_u32 m0, s85, 3072
    s_add_u32 s84, s84, s78
    buffer_load_dwordx4 v15, s[40:43], s83 offen offset:0  lds
    buffer_load_dwordx4 v16, s[40:43], s83 offen offset:1024  lds
    buffer_load_dwordx4 v17, s[40:43], s83 offen offset:2048  lds
    s_branch L_chunk
L_compute:
    s_mul_i32 s73, s4, 52
    s_lshr_b32 s73, s73, 8
    s_mul_i32 s74, s73, 5
    s_sub_u32 s74, s4, s74
    s_mov_b32 s58, 268435456
    s_mov_b32 s59, 0x20000
    s_lshl_b32 s32, s5, 5
    s_add_u32 s32, s32, s4
    s_lshl_b32 s32, s32, 2
    s_add_u32 s32, s32, s37
    s_lshl_b32 s32, s32, 2
    s_mul_i32 s34, s32, 128
    s_lshr_b32 s33, s34, 13
    s_lshl_b32 s33, s33, 13
    s_add_u32 s34, s34, s33
    s_add_u32 s34, s34, 51380224
    s_mul_i32 s33, s38, 32
    s_add_u32 s33, s33, s34
    s_mov_b32 s80, 1040356334
    s_mov_b32 s81, s80
    s_mov_b32 s82, 3187839982
    s_lshl_b32 s68, s3, 22
    s_and_b32 s69, s39, 3
    s_mul_i32 s69, s69, 393216
    s_add_u32 s68, s68, s69
    s_lshr_b32 s69, s39, 2
    s_lshl_b32 s71, s69, 13
    s_lshl_b32 s69, s69, 21
    s_add_u32 s68, s68, s69
    s_mul_i32 s69, s72, 3
    s_add_u32 s69, s69, 0
    s_lshr_b32 s70, s69, 3
    s_lshl_b32 s70, s70, 3
    s_add_u32 s69, s69, s70
    s_lshl_b32 s69, s69, 10
    s_add_u32 s48, s68, s69
    s_add_u32 s51, s48, 98304
    s_add_u32 s54, s48, 196608
    s_add_u32 s61, s48, 294912
    s_mul_i32 s69, s72, 3
    s_add_u32 s69, s69, 1
    s_lshr_b32 s70, s69, 3
    s_lshl_b32 s70, s70, 3
    s_add_u32 s69, s69, s70
    s_lshl_b32 s69, s69, 10
    s_add_u32 s49, s68, s69
    s_add_u32 s52, s49, 98304
    s_add_u32 s55, s49, 196608
    s_add_u32 s62, s49, 294912
    s_mul_i32 s69, s72, 3
    s_add_u32 s69, s69, 2
    s_lshr_b32 s70, s69, 3
    s_lshl_b32 s70, s70, 3
    s_add_u32 s69, s69, s70
    s_lshl_b32 s69, s69, 10
    s_add_u32 s50, s68, s69
    s_add_u32 s53, s50, 98304
    s_add_u32 s60, s50, 196608
    s_add_u32 s63, s50, 294912
    v_bfe_u32 v5, v0, 2, 2
    v_and_b32 v6, 1, v3
    v_lshl_or_b32 v6, v6, 2, v5
    v_lshl_add_u32 v5, v3, 3, v5
    v_lshlrev_b32 v5, 8, v5
    v_and_b32 v7, 3, v0
    v_lshl_add_u32 v5, v7, 3, v5
    v_xor_b32 v7, 0, v6
    v_lshl_add_u32 v8, v7, 5, v5
    v_xor_b32 v7, 1, v6
    v_lshl_add_u32 v9, v7, 5, v5
    v_xor_b32 v7, 2, v6
    v_lshl_add_u32 v10, v7, 5, v5
    v_xor_b32 v7, 3, v6
    v_lshl_add_u32 v11, v7, 5, v5
    v_xor_b32 v7, 4, v6
    v_lshl_add_u32 v12, v7, 5, v5
    v_xor_b32 v7, 5, v6
    v_lshl_add_u32 v13, v7, 5, v5
    v_xor_b32 v7, 6, v6
    v_lshl_add_u32 v14, v7, 5, v5
    v_xor_b32 v7, 7, v6
    v_lshl_add_u32 v15, v7, 5, v5
    s_mul_i32 s75, s37, 6144
    s_add_u32 s75, s75, 90112
    v_lshrrev_b32 v5, 1, v4
    v_xor_b32 v5, v5, v3
    v_lshlrev_b32 v5, 4, v5
    v_lshl_add_u32 v5, v4, 7, v5
    v_add_u32 v16, s75, v5
    v_xor_b32 v5, 64, v5
    v_add_u32 v17, s75, v5
    s_lshr_b32 s76, s37, 1
    v_lshrrev_b32 v5, 1, v3
    v_xor_b32 v5, v5, v4
    v_lshlrev_b32 v5, 4, v5
    v_lshl_add_u32 v5, v4, 8, v5
    v_and_b32 v6, 1, v3
    v_lshl_add_u32 v5, v6, 3, v5
    s_lshl_b32 s86, s76, 12
    s_add_u32 s86, s86, 24576
    v_add_u32 v248, s86, v5
    v_xor_b32 v249, 32, v248
    v_xor_b32 v250, 64, v248
    v_xor_b32 v251, 96, v248
    v_xor_b32 v252, 128, v248
    v_xor_b32 v253, 160, v248
    v_xor_b32 v254, 192, v248
    v_xor_b32 v255, 224, v248
    s_mul_i32 s77, s76, 24576
    s_add_u32 s77, s77, 114688
    v_lshlrev_b32 v5, 10, v3
    v_sub_u32 v23, s77, v5
    v_lshlrev_b32 v22, 4, v0
    s_waitcnt lgkmcnt(0)
    s_mov_b32 s44, s28
    s_mov_b32 s45, s29
    s_mov_b32 s46, 1966080
    s_mov_b32 s47, 0x20000
    s_lshl_b32 s13, s32, 14
    s_add_u32 s13, s13, 33554432
    s_bfe_u32 s23, s13, 0x10015
    s_lshl_b32 s23, s23, 13
    s_lshl_b32 s86, s38, 11
    s_add_u32 s86, s86, s13
    s_lshl_b32 s87, s38, 14
    s_add_u32 s87, s87, s13
    s_lshl_b32 s12, s76, 12
    s_add_u32 s12, s12, 114688
    s_add_u32 s11, s38, 1
    s_and_b32 s11, s11, 3
    s_lshl_b32 s14, s11, 14
    s_add_u32 s14, s14, s86
    s_lshl_b32 s17, s11, 11
    s_add_u32 s17, s17, s87
    s_lshl_b32 s24, s11, 10
    s_add_u32 s24, s24, s12
    s_add_u32 s11, s38, 2
    s_and_b32 s11, s11, 3
    s_lshl_b32 s15, s11, 14
    s_add_u32 s15, s15, s86
    s_lshl_b32 s18, s11, 11
    s_add_u32 s18, s18, s87
    s_lshl_b32 s25, s11, 10
    s_add_u32 s25, s25, s12
    s_add_u32 s11, s38, 3
    s_and_b32 s11, s11, 3
    s_lshl_b32 s16, s11, 14
    s_add_u32 s16, s16, s86
    s_lshl_b32 s19, s11, 11
    s_add_u32 s19, s19, s87
    s_lshl_b32 s26, s11, 10
    s_add_u32 s26, s26, s12
    s_add_u32 s11, s38, 4
    s_and_b32 s11, s11, 3
    s_lshl_b32 s27, s11, 10
    s_add_u32 s27, s27, s12
    s_mul_i32 s11, s38, 128
    s_add_u32 s11, s11, s34
    s_lshl_b32 s20, 1, s38
    s_xor_b32 s20, s20, 15
    s_mov_b32 s21, 0
    s_lshl_b32 s88, s73, 3
    s_lshl_b32 s89, s76, 2
    s_add_u32 s88, s88, s89
    s_add_u32 s88, s88, s38
    s_mul_i32 s88, s88, 40960
    s_mul_i32 s89, s5, 1280
    s_add_u32 s88, s88, s89
    s_lshl_b32 s89, s74, 8
    s_add_u32 s88, s88, s89
    s_and_b32 s89, s37, 1
    s_lshl_b32 s22, s89, 2
    s_lshl_b32 s89, s89, 7
    s_add_u32 s88, s88, s89
    v_add_u32 v21, s71, v22
    v_mov_b32 v5, 0
    v_mul_u32_u24 v20, 32, v0
    s_barrier
    ds_read_b64_tr_b16 v[24:25], v8 offset:0
    ds_read_b64_tr_b16 v[26:27], v8 offset:1024
    ds_read_b128 v[88:91], v16 offset:0
    ds_read_b64_tr_b16 v[56:57], v8 offset:8192
    ds_read_b64_tr_b16 v[58:59], v8 offset:9216
    ds_read_b128 v[100:103], v17 offset:0
    ds_read_b128 v[104:107], v17 offset:2048
    ds_read_b128 v[92:95], v16 offset:2048
    ds_read_b128 v[96:99], v16 offset:4096
    ds_read_b128 v[108:111], v17 offset:4096
    ds_read_b64_tr_b16 v[60:61], v9 offset:8192
    ds_read_b64_tr_b16 v[62:63], v9 offset:9216
    ds_read_b64_tr_b16 v[28:29], v9 offset:0
    ds_read_b64_tr_b16 v[30:31], v9 offset:1024
    s_waitcnt lgkmcnt(11)
    v_mfma_f32_16x16x32_bf16 v[112:115], v[24:27], v[88:91], 0
    ds_read_b64_tr_b16 v[32:33], v10 offset:0
    ds_read_b64_tr_b16 v[34:35], v10 offset:1024
    s_waitcnt lgkmcnt(10)
    v_mfma_f32_16x16x32_bf16 v[112:115], v[56:59], v[100:103], v[112:115]
    ds_read_b64_tr_b16 v[64:65], v10 offset:8192
    ds_read_b64_tr_b16 v[66:67], v10 offset:9216
    s_waitcnt lgkmcnt(9)
    v_mfma_f32_16x16x32_bf16 v[116:119], v[56:59], v[104:107], 0
    ds_read_b64_tr_b16 v[68:69], v11 offset:8192
    ds_read_b64_tr_b16 v[70:71], v11 offset:9216
    v_mfma_f32_16x16x32_bf16 v[116:119], v[24:27], v[92:95], v[116:119]
    ds_read_b64_tr_b16 v[36:37], v11 offset:0
    ds_read_b64_tr_b16 v[38:39], v11 offset:1024
    v_mfma_f32_16x16x32_bf16 v[120:123], v[24:27], v[96:99], 0
    ds_read_b64_tr_b16 v[40:41], v12 offset:0
    ds_read_b64_tr_b16 v[42:43], v12 offset:1024
    s_waitcnt lgkmcnt(8)
    v_mfma_f32_16x16x32_bf16 v[120:123], v[56:59], v[108:111], v[120:123]
    ds_read_b64_tr_b16 v[72:73], v12 offset:8192
    ds_read_b64_tr_b16 v[74:75], v12 offset:9216
    v_mfma_f32_16x16x32_bf16 v[132:135], v[60:63], v[108:111], 0
    ds_read_b64_tr_b16 v[76:77], v13 offset:8192
    ds_read_b64_tr_b16 v[78:79], v13 offset:9216
    v_mfma_f32_16x16x32_bf16 v[132:135], v[28:31], v[96:99], v[132:135]
    ds_read_b64_tr_b16 v[44:45], v13 offset:0
    ds_read_b64_tr_b16 v[46:47], v13 offset:1024
    v_mfma_f32_16x16x32_bf16 v[128:131], v[28:31], v[92:95], 0
    ds_read_b64_tr_b16 v[48:49], v14 offset:0
    ds_read_b64_tr_b16 v[50:51], v14 offset:1024
    v_mfma_f32_16x16x32_bf16 v[128:131], v[60:63], v[104:107], v[128:131]
    ds_read_b64_tr_b16 v[80:81], v14 offset:8192
    ds_read_b64_tr_b16 v[82:83], v14 offset:9216
    v_mfma_f32_16x16x32_bf16 v[124:127], v[60:63], v[100:103], 0
    ds_read_b64_tr_b16 v[84:85], v15 offset:8192
    ds_read_b64_tr_b16 v[86:87], v15 offset:9216
    v_mfma_f32_16x16x32_bf16 v[124:127], v[28:31], v[88:91], v[124:127]
    ds_read_b64_tr_b16 v[52:53], v15 offset:0
    ds_read_b64_tr_b16 v[54:55], v15 offset:1024
    v_mfma_f32_16x16x32_bf16 v[136:139], v[32:35], v[88:91], 0
    s_waitcnt lgkmcnt(8)
    v_mfma_f32_16x16x32_bf16 v[136:139], v[64:67], v[100:103], v[136:139]
    v_mfma_f32_16x16x32_bf16 v[140:143], v[64:67], v[104:107], 0
    v_mfma_f32_16x16x32_bf16 v[140:143], v[32:35], v[92:95], v[140:143]
    v_mfma_f32_16x16x32_bf16 v[144:147], v[32:35], v[96:99], 0
    v_mfma_f32_16x16x32_bf16 v[144:147], v[64:67], v[108:111], v[144:147]
    v_mfma_f32_16x16x32_bf16 v[156:159], v[68:71], v[108:111], 0
    v_mfma_f32_16x16x32_bf16 v[156:159], v[36:39], v[96:99], v[156:159]
    s_waitcnt lgkmcnt(0)
    s_barrier
    v_mfma_f32_16x16x32_bf16 v[152:155], v[36:39], v[92:95], 0
    ds_read_b64_tr_b16 v[24:25], v8 offset:16384
    ds_read_b64_tr_b16 v[26:27], v8 offset:17408
    v_mfma_f32_16x16x32_bf16 v[152:155], v[68:71], v[104:107], v[152:155]
    ds_read_b64_tr_b16 v[56:57], v8 offset:24576
    ds_read_b64_tr_b16 v[58:59], v8 offset:25600
    v_mfma_f32_16x16x32_bf16 v[148:151], v[68:71], v[100:103], 0
    ds_read_b64_tr_b16 v[60:61], v9 offset:24576
    ds_read_b64_tr_b16 v[62:63], v9 offset:25600
    v_mfma_f32_16x16x32_bf16 v[148:151], v[36:39], v[88:91], v[148:151]
    ds_read_b64_tr_b16 v[28:29], v9 offset:16384
    ds_read_b64_tr_b16 v[30:31], v9 offset:17408
    v_mfma_f32_16x16x32_bf16 v[160:163], v[40:43], v[88:91], 0
    ds_read_b64_tr_b16 v[32:33], v10 offset:16384
    ds_read_b64_tr_b16 v[34:35], v10 offset:17408
    v_mfma_f32_16x16x32_bf16 v[160:163], v[72:75], v[100:103], v[160:163]
    ds_read_b64_tr_b16 v[64:65], v10 offset:24576
    ds_read_b64_tr_b16 v[66:67], v10 offset:25600
    v_mfma_f32_16x16x32_bf16 v[164:167], v[72:75], v[104:107], 0
    ds_read_b64_tr_b16 v[68:69], v11 offset:24576
    ds_read_b64_tr_b16 v[70:71], v11 offset:25600
    v_mfma_f32_16x16x32_bf16 v[164:167], v[40:43], v[92:95], v[164:167]
    ds_read_b64_tr_b16 v[36:37], v11 offset:16384
    v_mfma_f32_16x16x32_bf16 v[168:171], v[40:43], v[96:99], 0
    ds_read_b64_tr_b16 v[38:39], v11 offset:17408
    v_mfma_f32_16x16x32_bf16 v[168:171], v[72:75], v[108:111], v[168:171]
    ds_read_b64_tr_b16 v[40:41], v12 offset:16384
    v_mfma_f32_16x16x32_bf16 v[180:183], v[76:79], v[108:111], 0
    ds_read_b64_tr_b16 v[42:43], v12 offset:17408
    v_mfma_f32_16x16x32_bf16 v[180:183], v[44:47], v[96:99], v[180:183]
    ds_read_b64_tr_b16 v[72:73], v12 offset:24576
    v_mfma_f32_16x16x32_bf16 v[176:179], v[44:47], v[92:95], 0
    ds_read_b64_tr_b16 v[74:75], v12 offset:25600
    v_mfma_f32_16x16x32_bf16 v[176:179], v[76:79], v[104:107], v[176:179]
    ds_read_b128 v[208:211], v16 offset:24576
    v_mfma_f32_16x16x32_bf16 v[172:175], v[76:79], v[100:103], 0
    ds_read_b128 v[220:223], v17 offset:24576
    v_mfma_f32_16x16x32_bf16 v[172:175], v[44:47], v[88:91], v[172:175]
    ds_read_b64_tr_b16 v[76:77], v13 offset:24576
    v_mfma_f32_16x16x32_bf16 v[184:187], v[48:51], v[88:91], 0
    ds_read_b64_tr_b16 v[78:79], v13 offset:25600
    v_mfma_f32_16x16x32_bf16 v[184:187], v[80:83], v[100:103], v[184:187]
    ds_read_b64_tr_b16 v[44:45], v13 offset:16384
    v_mfma_f32_16x16x32_bf16 v[188:191], v[80:83], v[104:107], 0
    ds_read_b64_tr_b16 v[46:47], v13 offset:17408
    v_mfma_f32_16x16x32_bf16 v[188:191], v[48:51], v[92:95], v[188:191]
    ds_read_b128 v[224:227], v17 offset:26624
    v_mfma_f32_16x16x32_bf16 v[192:195], v[48:51], v[96:99], 0
    ds_read_b128 v[212:215], v16 offset:26624
    v_mfma_f32_16x16x32_bf16 v[192:195], v[80:83], v[108:111], v[192:195]
    ds_read_b64_tr_b16 v[48:49], v14 offset:16384
    v_mfma_f32_16x16x32_bf16 v[204:207], v[84:87], v[108:111], 0
    ds_read_b64_tr_b16 v[50:51], v14 offset:17408
    v_mfma_f32_16x16x32_bf16 v[204:207], v[52:55], v[96:99], v[204:207]
    ds_read_b64_tr_b16 v[80:81], v14 offset:24576
    v_mfma_f32_16x16x32_bf16 v[200:203], v[52:55], v[92:95], 0
    ds_read_b64_tr_b16 v[82:83], v14 offset:25600
    v_mfma_f32_16x16x32_bf16 v[200:203], v[84:87], v[104:107], v[200:203]
    ds_read_b128 v[216:219], v16 offset:28672
    v_mfma_f32_16x16x32_bf16 v[196:199], v[84:87], v[100:103], 0
    ds_read_b128 v[228:231], v17 offset:28672
    v_mfma_f32_16x16x32_bf16 v[196:199], v[52:55], v[88:91], v[196:199]
    s_waitcnt lgkmcnt(6)
    v_mfma_f32_16x16x32_bf16 v[112:115], v[24:27], v[208:211], v[112:115]
    ds_read_b64_tr_b16 v[84:85], v15 offset:24576
    v_mfma_f32_16x16x32_bf16 v[112:115], v[56:59], v[220:223], v[112:115]
    ds_read_b64_tr_b16 v[86:87], v15 offset:25600
    v_mfma_f32_16x16x32_bf16 v[116:119], v[56:59], v[224:227], v[116:119]
    ds_read_b64_tr_b16 v[52:53], v15 offset:16384
    v_mfma_f32_16x16x32_bf16 v[116:119], v[24:27], v[212:215], v[116:119]
    ds_read_b64_tr_b16 v[54:55], v15 offset:17408
    s_waitcnt lgkmcnt(5)
    v_mfma_f32_16x16x32_bf16 v[120:123], v[24:27], v[216:219], v[120:123]
    s_waitcnt lgkmcnt(4)
    v_mfma_f32_16x16x32_bf16 v[120:123], v[56:59], v[228:231], v[120:123]
    v_mfma_f32_16x16x32_bf16 v[132:135], v[60:63], v[228:231], v[132:135]
    v_mfma_f32_16x16x32_bf16 v[132:135], v[28:31], v[216:219], v[132:135]
    v_mfma_f32_16x16x32_bf16 v[128:131], v[28:31], v[212:215], v[128:131]
    v_mfma_f32_16x16x32_bf16 v[128:131], v[60:63], v[224:227], v[128:131]
    v_mfma_f32_16x16x32_bf16 v[124:127], v[60:63], v[220:223], v[124:127]
    v_mfma_f32_16x16x32_bf16 v[124:127], v[28:31], v[208:211], v[124:127]
    v_mfma_f32_16x16x32_bf16 v[136:139], v[32:35], v[208:211], v[136:139]
    v_mfma_f32_16x16x32_bf16 v[136:139], v[64:67], v[220:223], v[136:139]
    s_waitcnt lgkmcnt(0)
    s_barrier
    v_mfma_f32_16x16x32_bf16 v[140:143], v[64:67], v[224:227], v[140:143]
    ds_read_b64_tr_b16 v[24:25], v8 offset:32768
    ds_read_b64_tr_b16 v[26:27], v8 offset:33792
    v_mfma_f32_16x16x32_bf16 v[140:143], v[32:35], v[212:215], v[140:143]
    ds_read_b64_tr_b16 v[56:57], v8 offset:40960
    v_mfma_f32_16x16x32_bf16 v[144:147], v[32:35], v[216:219], v[144:147]
    ds_read_b64_tr_b16 v[58:59], v8 offset:41984
    v_mfma_f32_16x16x32_bf16 v[144:147], v[64:67], v[228:231], v[144:147]
    ds_read_b64_tr_b16 v[60:61], v9 offset:40960
    v_mfma_f32_16x16x32_bf16 v[156:159], v[68:71], v[228:231], v[156:159]
    ds_read_b64_tr_b16 v[62:63], v9 offset:41984
    v_mfma_f32_16x16x32_bf16 v[156:159], v[36:39], v[216:219], v[156:159]
    ds_read_b64_tr_b16 v[28:29], v9 offset:32768
    v_mfma_f32_16x16x32_bf16 v[152:155], v[36:39], v[212:215], v[152:155]
    ds_read_b64_tr_b16 v[30:31], v9 offset:33792
    v_mfma_f32_16x16x32_bf16 v[152:155], v[68:71], v[224:227], v[152:155]
    ds_read_b64_tr_b16 v[32:33], v10 offset:32768
    v_mfma_f32_16x16x32_bf16 v[148:151], v[68:71], v[220:223], v[148:151]
    ds_read_b64_tr_b16 v[34:35], v10 offset:33792
    v_mfma_f32_16x16x32_bf16 v[148:151], v[36:39], v[208:211], v[148:151]
    ds_read_b64_tr_b16 v[64:65], v10 offset:40960
    v_mfma_f32_16x16x32_bf16 v[160:163], v[40:43], v[208:211], v[160:163]
    ds_read_b64_tr_b16 v[66:67], v10 offset:41984
    v_mfma_f32_16x16x32_bf16 v[160:163], v[72:75], v[220:223], v[160:163]
    ds_read_b64_tr_b16 v[68:69], v11 offset:40960
    v_mfma_f32_16x16x32_bf16 v[164:167], v[72:75], v[224:227], v[164:167]
    ds_read_b64_tr_b16 v[70:71], v11 offset:41984
    v_mfma_f32_16x16x32_bf16 v[164:167], v[40:43], v[212:215], v[164:167]
    ds_read_b64_tr_b16 v[36:37], v11 offset:32768
    v_mfma_f32_16x16x32_bf16 v[168:171], v[40:43], v[216:219], v[168:171]
    ds_read_b64_tr_b16 v[38:39], v11 offset:33792
    v_mfma_f32_16x16x32_bf16 v[168:171], v[72:75], v[228:231], v[168:171]
    ds_read_b64_tr_b16 v[40:41], v12 offset:32768
    v_mfma_f32_16x16x32_bf16 v[180:183], v[76:79], v[228:231], v[180:183]
    ds_read_b64_tr_b16 v[42:43], v12 offset:33792
    v_mfma_f32_16x16x32_bf16 v[180:183], v[44:47], v[216:219], v[180:183]
    ds_read_b64_tr_b16 v[72:73], v12 offset:40960
    v_mfma_f32_16x16x32_bf16 v[176:179], v[44:47], v[212:215], v[176:179]
    ds_read_b64_tr_b16 v[74:75], v12 offset:41984
    v_mfma_f32_16x16x32_bf16 v[176:179], v[76:79], v[224:227], v[176:179]
    ds_read_b128 v[88:91], v16 offset:49152
    v_mfma_f32_16x16x32_bf16 v[172:175], v[76:79], v[220:223], v[172:175]
    ds_read_b128 v[100:103], v17 offset:49152
    v_mfma_f32_16x16x32_bf16 v[172:175], v[44:47], v[208:211], v[172:175]
    ds_read_b64_tr_b16 v[76:77], v13 offset:40960
    v_mfma_f32_16x16x32_bf16 v[184:187], v[48:51], v[208:211], v[184:187]
    ds_read_b64_tr_b16 v[78:79], v13 offset:41984
    v_mfma_f32_16x16x32_bf16 v[184:187], v[80:83], v[220:223], v[184:187]
    ds_read_b64_tr_b16 v[44:45], v13 offset:32768
    v_mfma_f32_16x16x32_bf16 v[188:191], v[80:83], v[224:227], v[188:191]
    ds_read_b64_tr_b16 v[46:47], v13 offset:33792
    v_mfma_f32_16x16x32_bf16 v[188:191], v[48:51], v[212:215], v[188:191]
    ds_read_b128 v[104:107], v17 offset:51200
    v_mfma_f32_16x16x32_bf16 v[192:195], v[48:51], v[216:219], v[192:195]
    ds_read_b128 v[92:95], v16 offset:51200
    v_mfma_f32_16x16x32_bf16 v[192:195], v[80:83], v[228:231], v[192:195]
    ds_read_b64_tr_b16 v[48:49], v14 offset:32768
    v_mfma_f32_16x16x32_bf16 v[204:207], v[84:87], v[228:231], v[204:207]
    ds_read_b64_tr_b16 v[50:51], v14 offset:33792
    v_mfma_f32_16x16x32_bf16 v[204:207], v[52:55], v[216:219], v[204:207]
    ds_read_b64_tr_b16 v[80:81], v14 offset:40960
    v_mfma_f32_16x16x32_bf16 v[200:203], v[52:55], v[212:215], v[200:203]
    ds_read_b64_tr_b16 v[82:83], v14 offset:41984
    v_mfma_f32_16x16x32_bf16 v[200:203], v[84:87], v[224:227], v[200:203]
    ds_read_b128 v[96:99], v16 offset:53248
    v_mfma_f32_16x16x32_bf16 v[196:199], v[84:87], v[220:223], v[196:199]
    ds_read_b128 v[108:111], v17 offset:53248
    v_mfma_f32_16x16x32_bf16 v[196:199], v[52:55], v[208:211], v[196:199]
    s_waitcnt lgkmcnt(6)
    v_mfma_f32_16x16x32_bf16 v[112:115], v[24:27], v[88:91], v[112:115]
    ds_read_b64_tr_b16 v[84:85], v15 offset:40960
    v_mfma_f32_16x16x32_bf16 v[112:115], v[56:59], v[100:103], v[112:115]
    ds_read_b64_tr_b16 v[86:87], v15 offset:41984
    v_mfma_f32_16x16x32_bf16 v[116:119], v[56:59], v[104:107], v[116:119]
    ds_read_b64_tr_b16 v[52:53], v15 offset:32768
    v_mfma_f32_16x16x32_bf16 v[116:119], v[24:27], v[92:95], v[116:119]
    ds_read_b64_tr_b16 v[54:55], v15 offset:33792
    s_waitcnt lgkmcnt(5)
    v_mfma_f32_16x16x32_bf16 v[120:123], v[24:27], v[96:99], v[120:123]
    s_waitcnt lgkmcnt(4)
    v_mfma_f32_16x16x32_bf16 v[120:123], v[56:59], v[108:111], v[120:123]
    v_mfma_f32_16x16x32_bf16 v[132:135], v[60:63], v[108:111], v[132:135]
    v_mfma_f32_16x16x32_bf16 v[132:135], v[28:31], v[96:99], v[132:135]
    v_mfma_f32_16x16x32_bf16 v[128:131], v[28:31], v[92:95], v[128:131]
    v_mfma_f32_16x16x32_bf16 v[128:131], v[60:63], v[104:107], v[128:131]
    v_mfma_f32_16x16x32_bf16 v[124:127], v[60:63], v[100:103], v[124:127]
    v_mfma_f32_16x16x32_bf16 v[124:127], v[28:31], v[88:91], v[124:127]
    v_mfma_f32_16x16x32_bf16 v[136:139], v[32:35], v[88:91], v[136:139]
    v_mfma_f32_16x16x32_bf16 v[136:139], v[64:67], v[100:103], v[136:139]
    s_waitcnt lgkmcnt(0)
    s_barrier
    v_mfma_f32_16x16x32_bf16 v[140:143], v[64:67], v[104:107], v[140:143]
    ds_read_b64_tr_b16 v[24:25], v8 offset:0
    ds_read_b64_tr_b16 v[26:27], v8 offset:1024
    v_mfma_f32_16x16x32_bf16 v[140:143], v[32:35], v[92:95], v[140:143]
    ds_read_b64_tr_b16 v[56:57], v8 offset:8192
    v_mfma_f32_16x16x32_bf16 v[144:147], v[32:35], v[96:99], v[144:147]
    ds_read_b64_tr_b16 v[58:59], v8 offset:9216
    v_mfma_f32_16x16x32_bf16 v[144:147], v[64:67], v[108:111], v[144:147]
    ds_read_b64_tr_b16 v[60:61], v9 offset:8192
    v_mfma_f32_16x16x32_bf16 v[156:159], v[68:71], v[108:111], v[156:159]
    ds_read_b64_tr_b16 v[62:63], v9 offset:9216
    v_mfma_f32_16x16x32_bf16 v[156:159], v[36:39], v[96:99], v[156:159]
    ds_read_b64_tr_b16 v[28:29], v9 offset:0
    v_mfma_f32_16x16x32_bf16 v[152:155], v[36:39], v[92:95], v[152:155]
    ds_read_b64_tr_b16 v[30:31], v9 offset:1024
    v_mfma_f32_16x16x32_bf16 v[152:155], v[68:71], v[104:107], v[152:155]
    ds_read_b64_tr_b16 v[32:33], v10 offset:0
    v_mfma_f32_16x16x32_bf16 v[148:151], v[68:71], v[100:103], v[148:151]
    ds_read_b64_tr_b16 v[34:35], v10 offset:1024
    v_mfma_f32_16x16x32_bf16 v[148:151], v[36:39], v[88:91], v[148:151]
    ds_read_b64_tr_b16 v[64:65], v10 offset:8192
    v_mfma_f32_16x16x32_bf16 v[160:163], v[40:43], v[88:91], v[160:163]
    ds_read_b64_tr_b16 v[66:67], v10 offset:9216
    v_mfma_f32_16x16x32_bf16 v[160:163], v[72:75], v[100:103], v[160:163]
    ds_read_b64_tr_b16 v[68:69], v11 offset:8192
    v_mfma_f32_16x16x32_bf16 v[164:167], v[72:75], v[104:107], v[164:167]
    ds_read_b64_tr_b16 v[70:71], v11 offset:9216
    v_mfma_f32_16x16x32_bf16 v[164:167], v[40:43], v[92:95], v[164:167]
    ds_read_b64_tr_b16 v[36:37], v11 offset:0
    v_mfma_f32_16x16x32_bf16 v[168:171], v[40:43], v[96:99], v[168:171]
    ds_read_b64_tr_b16 v[38:39], v11 offset:1024
    v_mfma_f32_16x16x32_bf16 v[168:171], v[72:75], v[108:111], v[168:171]
    ds_read_b64_tr_b16 v[40:41], v12 offset:0
    v_mfma_f32_16x16x32_bf16 v[180:183], v[76:79], v[108:111], v[180:183]
    ds_read_b64_tr_b16 v[42:43], v12 offset:1024
    v_mfma_f32_16x16x32_bf16 v[180:183], v[44:47], v[96:99], v[180:183]
    ds_read_b64_tr_b16 v[72:73], v12 offset:8192
    v_mfma_f32_16x16x32_bf16 v[176:179], v[44:47], v[92:95], v[176:179]
    ds_read_b64_tr_b16 v[74:75], v12 offset:9216
    v_mfma_f32_16x16x32_bf16 v[176:179], v[76:79], v[104:107], v[176:179]
    ds_read_b128 v[208:211], v16 offset:0
    v_mfma_f32_16x16x32_bf16 v[172:175], v[76:79], v[100:103], v[172:175]
    ds_read_b128 v[220:223], v17 offset:0
    v_mfma_f32_16x16x32_bf16 v[172:175], v[44:47], v[88:91], v[172:175]
    ds_read_b64_tr_b16 v[76:77], v13 offset:8192
    v_mfma_f32_16x16x32_bf16 v[184:187], v[48:51], v[88:91], v[184:187]
    ds_read_b64_tr_b16 v[78:79], v13 offset:9216
    v_mfma_f32_16x16x32_bf16 v[184:187], v[80:83], v[100:103], v[184:187]
    ds_read_b64_tr_b16 v[44:45], v13 offset:0
    v_mfma_f32_16x16x32_bf16 v[188:191], v[80:83], v[104:107], v[188:191]
    ds_read_b64_tr_b16 v[46:47], v13 offset:1024
    v_mfma_f32_16x16x32_bf16 v[188:191], v[48:51], v[92:95], v[188:191]
    ds_read_b128 v[224:227], v17 offset:2048
    v_mfma_f32_16x16x32_bf16 v[192:195], v[48:51], v[96:99], v[192:195]
    ds_read_b128 v[212:215], v16 offset:2048
    v_mfma_f32_16x16x32_bf16 v[192:195], v[80:83], v[108:111], v[192:195]
    ds_read_b64_tr_b16 v[48:49], v14 offset:0
    v_mfma_f32_16x16x32_bf16 v[204:207], v[84:87], v[108:111], v[204:207]
    ds_read_b64_tr_b16 v[50:51], v14 offset:1024
    v_mfma_f32_16x16x32_bf16 v[204:207], v[52:55], v[96:99], v[204:207]
    ds_read_b64_tr_b16 v[80:81], v14 offset:8192
    v_mfma_f32_16x16x32_bf16 v[200:203], v[52:55], v[92:95], v[200:203]
    ds_read_b64_tr_b16 v[82:83], v14 offset:9216
    v_mfma_f32_16x16x32_bf16 v[200:203], v[84:87], v[104:107], v[200:203]
    ds_read_b128 v[216:219], v16 offset:4096
    v_mfma_f32_16x16x32_bf16 v[196:199], v[84:87], v[100:103], v[196:199]
    ds_read_b128 v[228:231], v17 offset:4096
    v_mfma_f32_16x16x32_bf16 v[196:199], v[52:55], v[88:91], v[196:199]
    s_waitcnt lgkmcnt(6)
    v_mfma_f32_16x16x32_bf16 v[112:115], v[24:27], v[208:211], v[112:115]
    ds_read_b64_tr_b16 v[84:85], v15 offset:8192
    v_mfma_f32_16x16x32_bf16 v[112:115], v[56:59], v[220:223], v[112:115]
    ds_read_b64_tr_b16 v[86:87], v15 offset:9216
    v_mfma_f32_16x16x32_bf16 v[116:119], v[56:59], v[224:227], v[116:119]
    ds_read_b64_tr_b16 v[52:53], v15 offset:0
    v_mfma_f32_16x16x32_bf16 v[116:119], v[24:27], v[212:215], v[116:119]
    ds_read_b64_tr_b16 v[54:55], v15 offset:1024
    s_waitcnt lgkmcnt(5)
    v_mfma_f32_16x16x32_bf16 v[120:123], v[24:27], v[216:219], v[120:123]
    s_waitcnt lgkmcnt(4)
    v_mfma_f32_16x16x32_bf16 v[120:123], v[56:59], v[228:231], v[120:123]
    v_mfma_f32_16x16x32_bf16 v[132:135], v[60:63], v[228:231], v[132:135]
    v_mfma_f32_16x16x32_bf16 v[132:135], v[28:31], v[216:219], v[132:135]
    v_mfma_f32_16x16x32_bf16 v[128:131], v[28:31], v[212:215], v[128:131]
    v_mfma_f32_16x16x32_bf16 v[128:131], v[60:63], v[224:227], v[128:131]
    v_mfma_f32_16x16x32_bf16 v[124:127], v[60:63], v[220:223], v[124:127]
    v_mfma_f32_16x16x32_bf16 v[124:127], v[28:31], v[208:211], v[124:127]
    v_mfma_f32_16x16x32_bf16 v[136:139], v[32:35], v[208:211], v[136:139]
    v_mfma_f32_16x16x32_bf16 v[136:139], v[64:67], v[220:223], v[136:139]
    s_waitcnt lgkmcnt(0)
    s_barrier
    v_mfma_f32_16x16x32_bf16 v[140:143], v[64:67], v[224:227], v[140:143]
    ds_read_b64_tr_b16 v[24:25], v8 offset:16384
    ds_read_b64_tr_b16 v[26:27], v8 offset:17408
    v_mfma_f32_16x16x32_bf16 v[140:143], v[32:35], v[212:215], v[140:143]
    ds_read_b64_tr_b16 v[56:57], v8 offset:24576
    v_mfma_f32_16x16x32_bf16 v[144:147], v[32:35], v[216:219], v[144:147]
    ds_read_b64_tr_b16 v[58:59], v8 offset:25600
    v_mfma_f32_16x16x32_bf16 v[144:147], v[64:67], v[228:231], v[144:147]
    ds_read_b64_tr_b16 v[60:61], v9 offset:24576
    v_mfma_f32_16x16x32_bf16 v[156:159], v[68:71], v[228:231], v[156:159]
    ds_read_b64_tr_b16 v[62:63], v9 offset:25600
    v_mfma_f32_16x16x32_bf16 v[156:159], v[36:39], v[216:219], v[156:159]
    ds_read_b64_tr_b16 v[28:29], v9 offset:16384
    v_mfma_f32_16x16x32_bf16 v[152:155], v[36:39], v[212:215], v[152:155]
    ds_read_b64_tr_b16 v[30:31], v9 offset:17408
    v_mfma_f32_16x16x32_bf16 v[152:155], v[68:71], v[224:227], v[152:155]
    ds_read_b64_tr_b16 v[32:33], v10 offset:16384
    v_mfma_f32_16x16x32_bf16 v[148:151], v[68:71], v[220:223], v[148:151]
    ds_read_b64_tr_b16 v[34:35], v10 offset:17408
    v_mfma_f32_16x16x32_bf16 v[148:151], v[36:39], v[208:211], v[148:151]
    ds_read_b64_tr_b16 v[64:65], v10 offset:24576
    v_mfma_f32_16x16x32_bf16 v[160:163], v[40:43], v[208:211], v[160:163]
    ds_read_b64_tr_b16 v[66:67], v10 offset:25600
    v_mfma_f32_16x16x32_bf16 v[160:163], v[72:75], v[220:223], v[160:163]
    ds_read_b64_tr_b16 v[68:69], v11 offset:24576
    v_mfma_f32_16x16x32_bf16 v[164:167], v[72:75], v[224:227], v[164:167]
    ds_read_b64_tr_b16 v[70:71], v11 offset:25600
    v_mfma_f32_16x16x32_bf16 v[164:167], v[40:43], v[212:215], v[164:167]
    ds_read_b64_tr_b16 v[36:37], v11 offset:16384
    v_mfma_f32_16x16x32_bf16 v[168:171], v[40:43], v[216:219], v[168:171]
    ds_read_b64_tr_b16 v[38:39], v11 offset:17408
    v_mfma_f32_16x16x32_bf16 v[168:171], v[72:75], v[228:231], v[168:171]
    ds_read_b64_tr_b16 v[40:41], v12 offset:16384
    v_mfma_f32_16x16x32_bf16 v[180:183], v[76:79], v[228:231], v[180:183]
    ds_read_b64_tr_b16 v[42:43], v12 offset:17408
    v_mfma_f32_16x16x32_bf16 v[180:183], v[44:47], v[216:219], v[180:183]
    ds_read_b64_tr_b16 v[72:73], v12 offset:24576
    v_mfma_f32_16x16x32_bf16 v[176:179], v[44:47], v[212:215], v[176:179]
    ds_read_b64_tr_b16 v[74:75], v12 offset:25600
    v_mfma_f32_16x16x32_bf16 v[176:179], v[76:79], v[224:227], v[176:179]
    ds_read_b128 v[88:91], v16 offset:24576
    v_mfma_f32_16x16x32_bf16 v[172:175], v[76:79], v[220:223], v[172:175]
    ds_read_b128 v[100:103], v17 offset:24576
    v_mfma_f32_16x16x32_bf16 v[172:175], v[44:47], v[208:211], v[172:175]
    ds_read_b64_tr_b16 v[76:77], v13 offset:24576
    v_mfma_f32_16x16x32_bf16 v[184:187], v[48:51], v[208:211], v[184:187]
    ds_read_b64_tr_b16 v[78:79], v13 offset:25600
    v_mfma_f32_16x16x32_bf16 v[184:187], v[80:83], v[220:223], v[184:187]
    ds_read_b64_tr_b16 v[44:45], v13 offset:16384
    v_mfma_f32_16x16x32_bf16 v[188:191], v[80:83], v[224:227], v[188:191]
    ds_read_b64_tr_b16 v[46:47], v13 offset:17408
    v_mfma_f32_16x16x32_bf16 v[188:191], v[48:51], v[212:215], v[188:191]
    ds_read_b128 v[104:107], v17 offset:26624
    v_mfma_f32_16x16x32_bf16 v[192:195], v[48:51], v[216:219], v[192:195]
    ds_read_b128 v[92:95], v16 offset:26624
    v_mfma_f32_16x16x32_bf16 v[192:195], v[80:83], v[228:231], v[192:195]
    ds_read_b64_tr_b16 v[48:49], v14 offset:16384
    v_mfma_f32_16x16x32_bf16 v[204:207], v[84:87], v[228:231], v[204:207]
    ds_read_b64_tr_b16 v[50:51], v14 offset:17408
    v_mfma_f32_16x16x32_bf16 v[204:207], v[52:55], v[216:219], v[204:207]
    ds_read_b64_tr_b16 v[80:81], v14 offset:24576
    v_mfma_f32_16x16x32_bf16 v[200:203], v[52:55], v[212:215], v[200:203]
    ds_read_b64_tr_b16 v[82:83], v14 offset:25600
    v_mfma_f32_16x16x32_bf16 v[200:203], v[84:87], v[224:227], v[200:203]
    ds_read_b128 v[96:99], v16 offset:28672
    v_mfma_f32_16x16x32_bf16 v[196:199], v[84:87], v[220:223], v[196:199]
    ds_read_b128 v[108:111], v17 offset:28672
    v_mfma_f32_16x16x32_bf16 v[196:199], v[52:55], v[208:211], v[196:199]
    s_waitcnt lgkmcnt(6)
    v_mfma_f32_16x16x32_bf16 v[112:115], v[24:27], v[88:91], v[112:115]
    ds_read_b64_tr_b16 v[84:85], v15 offset:24576
    v_mfma_f32_16x16x32_bf16 v[112:115], v[56:59], v[100:103], v[112:115]
    ds_read_b64_tr_b16 v[86:87], v15 offset:25600
    v_mfma_f32_16x16x32_bf16 v[116:119], v[56:59], v[104:107], v[116:119]
    ds_read_b64_tr_b16 v[52:53], v15 offset:16384
    v_mfma_f32_16x16x32_bf16 v[116:119], v[24:27], v[92:95], v[116:119]
    ds_read_b64_tr_b16 v[54:55], v15 offset:17408
    s_waitcnt lgkmcnt(5)
    v_mfma_f32_16x16x32_bf16 v[120:123], v[24:27], v[96:99], v[120:123]
    s_waitcnt lgkmcnt(4)
    v_mfma_f32_16x16x32_bf16 v[120:123], v[56:59], v[108:111], v[120:123]
    v_mfma_f32_16x16x32_bf16 v[132:135], v[60:63], v[108:111], v[132:135]
    v_mfma_f32_16x16x32_bf16 v[132:135], v[28:31], v[96:99], v[132:135]
    v_mfma_f32_16x16x32_bf16 v[128:131], v[28:31], v[92:95], v[128:131]
    v_mfma_f32_16x16x32_bf16 v[128:131], v[60:63], v[104:107], v[128:131]
    v_mfma_f32_16x16x32_bf16 v[124:127], v[60:63], v[100:103], v[124:127]
    v_mfma_f32_16x16x32_bf16 v[124:127], v[28:31], v[88:91], v[124:127]
    v_mfma_f32_16x16x32_bf16 v[136:139], v[32:35], v[88:91], v[136:139]
    v_mfma_f32_16x16x32_bf16 v[136:139], v[64:67], v[100:103], v[136:139]
    s_waitcnt lgkmcnt(0)
    s_barrier
    v_mfma_f32_16x16x32_bf16 v[140:143], v[64:67], v[104:107], v[140:143]
    ds_read_b64_tr_b16 v[24:25], v8 offset:32768
    ds_read_b64_tr_b16 v[26:27], v8 offset:33792
    v_mfma_f32_16x16x32_bf16 v[140:143], v[32:35], v[92:95], v[140:143]
    ds_read_b64_tr_b16 v[56:57], v8 offset:40960
    v_mfma_f32_16x16x32_bf16 v[144:147], v[32:35], v[96:99], v[144:147]
    ds_read_b64_tr_b16 v[58:59], v8 offset:41984
    v_mfma_f32_16x16x32_bf16 v[144:147], v[64:67], v[108:111], v[144:147]
    ds_read_b64_tr_b16 v[60:61], v9 offset:40960
    v_mfma_f32_16x16x32_bf16 v[156:159], v[68:71], v[108:111], v[156:159]
    ds_read_b64_tr_b16 v[62:63], v9 offset:41984
    v_mfma_f32_16x16x32_bf16 v[156:159], v[36:39], v[96:99], v[156:159]
    ds_read_b64_tr_b16 v[28:29], v9 offset:32768
    v_mfma_f32_16x16x32_bf16 v[152:155], v[36:39], v[92:95], v[152:155]
    ds_read_b64_tr_b16 v[30:31], v9 offset:33792
    v_mfma_f32_16x16x32_bf16 v[152:155], v[68:71], v[104:107], v[152:155]
    ds_read_b64_tr_b16 v[32:33], v10 offset:32768
    v_mfma_f32_16x16x32_bf16 v[148:151], v[68:71], v[100:103], v[148:151]
    ds_read_b64_tr_b16 v[34:35], v10 offset:33792
    v_mfma_f32_16x16x32_bf16 v[148:151], v[36:39], v[88:91], v[148:151]
    ds_read_b64_tr_b16 v[64:65], v10 offset:40960
    v_mfma_f32_16x16x32_bf16 v[160:163], v[40:43], v[88:91], v[160:163]
    ds_read_b64_tr_b16 v[66:67], v10 offset:41984
    v_mfma_f32_16x16x32_bf16 v[160:163], v[72:75], v[100:103], v[160:163]
    ds_read_b64_tr_b16 v[68:69], v11 offset:40960
    v_mfma_f32_16x16x32_bf16 v[164:167], v[72:75], v[104:107], v[164:167]
    ds_read_b64_tr_b16 v[70:71], v11 offset:41984
    v_mfma_f32_16x16x32_bf16 v[164:167], v[40:43], v[92:95], v[164:167]
    ds_read_b64_tr_b16 v[36:37], v11 offset:32768
    v_mfma_f32_16x16x32_bf16 v[168:171], v[40:43], v[96:99], v[168:171]
    ds_read_b64_tr_b16 v[38:39], v11 offset:33792
    v_mfma_f32_16x16x32_bf16 v[168:171], v[72:75], v[108:111], v[168:171]
    ds_read_b64_tr_b16 v[40:41], v12 offset:32768
    v_mfma_f32_16x16x32_bf16 v[180:183], v[76:79], v[108:111], v[180:183]
    ds_read_b64_tr_b16 v[42:43], v12 offset:33792
    v_mfma_f32_16x16x32_bf16 v[180:183], v[44:47], v[96:99], v[180:183]
    ds_read_b64_tr_b16 v[72:73], v12 offset:40960
    v_mfma_f32_16x16x32_bf16 v[176:179], v[44:47], v[92:95], v[176:179]
    ds_read_b64_tr_b16 v[74:75], v12 offset:41984
    v_mfma_f32_16x16x32_bf16 v[176:179], v[76:79], v[104:107], v[176:179]
    ds_read_b128 v[208:211], v16 offset:49152
    v_mfma_f32_16x16x32_bf16 v[172:175], v[76:79], v[100:103], v[172:175]
    ds_read_b128 v[220:223], v17 offset:49152
    v_mfma_f32_16x16x32_bf16 v[172:175], v[44:47], v[88:91], v[172:175]
    ds_read_b64_tr_b16 v[76:77], v13 offset:40960
    v_mfma_f32_16x16x32_bf16 v[184:187], v[48:51], v[88:91], v[184:187]
    ds_read_b64_tr_b16 v[78:79], v13 offset:41984
    v_mfma_f32_16x16x32_bf16 v[184:187], v[80:83], v[100:103], v[184:187]
    ds_read_b64_tr_b16 v[44:45], v13 offset:32768
    v_mfma_f32_16x16x32_bf16 v[188:191], v[80:83], v[104:107], v[188:191]
    ds_read_b64_tr_b16 v[46:47], v13 offset:33792
    v_mfma_f32_16x16x32_bf16 v[188:191], v[48:51], v[92:95], v[188:191]
    ds_read_b128 v[224:227], v17 offset:51200
    v_mfma_f32_16x16x32_bf16 v[192:195], v[48:51], v[96:99], v[192:195]
    ds_read_b128 v[212:215], v16 offset:51200
    v_mfma_f32_16x16x32_bf16 v[192:195], v[80:83], v[108:111], v[192:195]
    ds_read_b64_tr_b16 v[48:49], v14 offset:32768
    v_mfma_f32_16x16x32_bf16 v[204:207], v[84:87], v[108:111], v[204:207]
    ds_read_b64_tr_b16 v[50:51], v14 offset:33792
    v_mfma_f32_16x16x32_bf16 v[204:207], v[52:55], v[96:99], v[204:207]
    ds_read_b64_tr_b16 v[80:81], v14 offset:40960
    v_mfma_f32_16x16x32_bf16 v[200:203], v[52:55], v[92:95], v[200:203]
    ds_read_b64_tr_b16 v[82:83], v14 offset:41984
    v_mfma_f32_16x16x32_bf16 v[200:203], v[84:87], v[104:107], v[200:203]
    ds_read_b128 v[216:219], v16 offset:53248
    v_mfma_f32_16x16x32_bf16 v[196:199], v[84:87], v[100:103], v[196:199]
    ds_read_b128 v[228:231], v17 offset:53248
    v_mfma_f32_16x16x32_bf16 v[196:199], v[52:55], v[88:91], v[196:199]
    s_waitcnt lgkmcnt(6)
    v_mfma_f32_16x16x32_bf16 v[112:115], v[24:27], v[208:211], v[112:115]
    ds_read_b64_tr_b16 v[84:85], v15 offset:40960
    v_mfma_f32_16x16x32_bf16 v[112:115], v[56:59], v[220:223], v[112:115]
    ds_read_b64_tr_b16 v[86:87], v15 offset:41984
    v_mfma_f32_16x16x32_bf16 v[116:119], v[56:59], v[224:227], v[116:119]
    ds_read_b64_tr_b16 v[52:53], v15 offset:32768
    v_mfma_f32_16x16x32_bf16 v[116:119], v[24:27], v[212:215], v[116:119]
    ds_read_b64_tr_b16 v[54:55], v15 offset:33792
    s_waitcnt lgkmcnt(5)
    v_mfma_f32_16x16x32_bf16 v[120:123], v[24:27], v[216:219], v[120:123]
    s_waitcnt lgkmcnt(4)
    v_mfma_f32_16x16x32_bf16 v[120:123], v[56:59], v[228:231], v[120:123]
    v_mfma_f32_16x16x32_bf16 v[132:135], v[60:63], v[228:231], v[132:135]
    v_mfma_f32_16x16x32_bf16 v[132:135], v[28:31], v[216:219], v[132:135]
    v_mfma_f32_16x16x32_bf16 v[128:131], v[28:31], v[212:215], v[128:131]
    v_mfma_f32_16x16x32_bf16 v[128:131], v[60:63], v[224:227], v[128:131]
    v_mfma_f32_16x16x32_bf16 v[124:127], v[60:63], v[220:223], v[124:127]
    v_mfma_f32_16x16x32_bf16 v[124:127], v[28:31], v[208:211], v[124:127]
    v_mfma_f32_16x16x32_bf16 v[136:139], v[32:35], v[208:211], v[136:139]
    v_mfma_f32_16x16x32_bf16 v[136:139], v[64:67], v[220:223], v[136:139]
    s_waitcnt lgkmcnt(0)
    s_barrier
    v_mfma_f32_16x16x32_bf16 v[140:143], v[64:67], v[224:227], v[140:143]
    ds_read_b64_tr_b16 v[24:25], v8 offset:0
    ds_read_b64_tr_b16 v[26:27], v8 offset:1024
    v_mfma_f32_16x16x32_bf16 v[140:143], v[32:35], v[212:215], v[140:143]
    ds_read_b64_tr_b16 v[56:57], v8 offset:8192
    v_mfma_f32_16x16x32_bf16 v[144:147], v[32:35], v[216:219], v[144:147]
    ds_read_b64_tr_b16 v[58:59], v8 offset:9216
    v_mfma_f32_16x16x32_bf16 v[144:147], v[64:67], v[228:231], v[144:147]
    ds_read_b64_tr_b16 v[60:61], v9 offset:8192
    v_mfma_f32_16x16x32_bf16 v[156:159], v[68:71], v[228:231], v[156:159]
    ds_read_b64_tr_b16 v[62:63], v9 offset:9216
    v_mfma_f32_16x16x32_bf16 v[156:159], v[36:39], v[216:219], v[156:159]
    ds_read_b64_tr_b16 v[28:29], v9 offset:0
    v_mfma_f32_16x16x32_bf16 v[152:155], v[36:39], v[212:215], v[152:155]
    ds_read_b64_tr_b16 v[30:31], v9 offset:1024
    v_mfma_f32_16x16x32_bf16 v[152:155], v[68:71], v[224:227], v[152:155]
    ds_read_b64_tr_b16 v[32:33], v10 offset:0
    v_mfma_f32_16x16x32_bf16 v[148:151], v[68:71], v[220:223], v[148:151]
    ds_read_b64_tr_b16 v[34:35], v10 offset:1024
    v_mfma_f32_16x16x32_bf16 v[148:151], v[36:39], v[208:211], v[148:151]
    ds_read_b64_tr_b16 v[64:65], v10 offset:8192
    v_mfma_f32_16x16x32_bf16 v[160:163], v[40:43], v[208:211], v[160:163]
    ds_read_b64_tr_b16 v[66:67], v10 offset:9216
    v_mfma_f32_16x16x32_bf16 v[160:163], v[72:75], v[220:223], v[160:163]
    ds_read_b64_tr_b16 v[68:69], v11 offset:8192
    v_mfma_f32_16x16x32_bf16 v[164:167], v[72:75], v[224:227], v[164:167]
    ds_read_b64_tr_b16 v[70:71], v11 offset:9216
    v_mfma_f32_16x16x32_bf16 v[164:167], v[40:43], v[212:215], v[164:167]
    ds_read_b64_tr_b16 v[36:37], v11 offset:0
    v_mfma_f32_16x16x32_bf16 v[168:171], v[40:43], v[216:219], v[168:171]
    ds_read_b64_tr_b16 v[38:39], v11 offset:1024
    v_mfma_f32_16x16x32_bf16 v[168:171], v[72:75], v[228:231], v[168:171]
    ds_read_b64_tr_b16 v[40:41], v12 offset:0
    v_mfma_f32_16x16x32_bf16 v[180:183], v[76:79], v[228:231], v[180:183]
    ds_read_b64_tr_b16 v[42:43], v12 offset:1024
    v_mfma_f32_16x16x32_bf16 v[180:183], v[44:47], v[216:219], v[180:183]
    ds_read_b64_tr_b16 v[72:73], v12 offset:8192
    v_mfma_f32_16x16x32_bf16 v[176:179], v[44:47], v[212:215], v[176:179]
    ds_read_b64_tr_b16 v[74:75], v12 offset:9216
    v_mfma_f32_16x16x32_bf16 v[176:179], v[76:79], v[224:227], v[176:179]
    ds_read_b128 v[88:91], v16 offset:0
    v_mfma_f32_16x16x32_bf16 v[172:175], v[76:79], v[220:223], v[172:175]
    ds_read_b128 v[100:103], v17 offset:0
    v_mfma_f32_16x16x32_bf16 v[172:175], v[44:47], v[208:211], v[172:175]
    ds_read_b64_tr_b16 v[76:77], v13 offset:8192
    v_mfma_f32_16x16x32_bf16 v[184:187], v[48:51], v[208:211], v[184:187]
    ds_read_b64_tr_b16 v[78:79], v13 offset:9216
    v_mfma_f32_16x16x32_bf16 v[184:187], v[80:83], v[220:223], v[184:187]
    ds_read_b64_tr_b16 v[44:45], v13 offset:0
    v_mfma_f32_16x16x32_bf16 v[188:191], v[80:83], v[224:227], v[188:191]
    ds_read_b64_tr_b16 v[46:47], v13 offset:1024
    v_mfma_f32_16x16x32_bf16 v[188:191], v[48:51], v[212:215], v[188:191]
    ds_read_b128 v[104:107], v17 offset:2048
    v_mfma_f32_16x16x32_bf16 v[192:195], v[48:51], v[216:219], v[192:195]
    ds_read_b128 v[92:95], v16 offset:2048
    v_mfma_f32_16x16x32_bf16 v[192:195], v[80:83], v[228:231], v[192:195]
    ds_read_b64_tr_b16 v[48:49], v14 offset:0
    v_mfma_f32_16x16x32_bf16 v[204:207], v[84:87], v[228:231], v[204:207]
    ds_read_b64_tr_b16 v[50:51], v14 offset:1024
    v_mfma_f32_16x16x32_bf16 v[204:207], v[52:55], v[216:219], v[204:207]
    ds_read_b64_tr_b16 v[80:81], v14 offset:8192
    v_mfma_f32_16x16x32_bf16 v[200:203], v[52:55], v[212:215], v[200:203]
    ds_read_b64_tr_b16 v[82:83], v14 offset:9216
    v_mfma_f32_16x16x32_bf16 v[200:203], v[84:87], v[224:227], v[200:203]
    ds_read_b128 v[96:99], v16 offset:4096
    v_mfma_f32_16x16x32_bf16 v[196:199], v[84:87], v[220:223], v[196:199]
    ds_read_b128 v[108:111], v17 offset:4096
    v_mfma_f32_16x16x32_bf16 v[196:199], v[52:55], v[208:211], v[196:199]
    s_waitcnt lgkmcnt(6)
    v_mfma_f32_16x16x32_bf16 v[112:115], v[24:27], v[88:91], v[112:115]
    ds_read_b64_tr_b16 v[84:85], v15 offset:8192
    v_mfma_f32_16x16x32_bf16 v[112:115], v[56:59], v[100:103], v[112:115]
    ds_read_b64_tr_b16 v[86:87], v15 offset:9216
    v_mfma_f32_16x16x32_bf16 v[116:119], v[56:59], v[104:107], v[116:119]
    ds_read_b64_tr_b16 v[52:53], v15 offset:0
    v_mfma_f32_16x16x32_bf16 v[116:119], v[24:27], v[92:95], v[116:119]
    ds_read_b64_tr_b16 v[54:55], v15 offset:1024
    s_waitcnt lgkmcnt(5)
    v_mfma_f32_16x16x32_bf16 v[120:123], v[24:27], v[96:99], v[120:123]
    s_waitcnt lgkmcnt(4)
    v_mfma_f32_16x16x32_bf16 v[120:123], v[56:59], v[108:111], v[120:123]
    v_mfma_f32_16x16x32_bf16 v[132:135], v[60:63], v[108:111], v[132:135]
    v_mfma_f32_16x16x32_bf16 v[132:135], v[28:31], v[96:99], v[132:135]
    v_mfma_f32_16x16x32_bf16 v[128:131], v[28:31], v[92:95], v[128:131]
    v_mfma_f32_16x16x32_bf16 v[128:131], v[60:63], v[104:107], v[128:131]
    v_mfma_f32_16x16x32_bf16 v[124:127], v[60:63], v[100:103], v[124:127]
    v_mfma_f32_16x16x32_bf16 v[124:127], v[28:31], v[88:91], v[124:127]
    v_mfma_f32_16x16x32_bf16 v[136:139], v[32:35], v[88:91], v[136:139]
    v_mfma_f32_16x16x32_bf16 v[136:139], v[64:67], v[100:103], v[136:139]
    s_waitcnt lgkmcnt(0)
    s_barrier
    v_mfma_f32_16x16x32_bf16 v[140:143], v[64:67], v[104:107], v[140:143]
    ds_read_b64_tr_b16 v[24:25], v8 offset:16384
    ds_read_b64_tr_b16 v[26:27], v8 offset:17408
    v_mfma_f32_16x16x32_bf16 v[140:143], v[32:35], v[92:95], v[140:143]
    ds_read_b64_tr_b16 v[56:57], v8 offset:24576
    v_mfma_f32_16x16x32_bf16 v[144:147], v[32:35], v[96:99], v[144:147]
    ds_read_b64_tr_b16 v[58:59], v8 offset:25600
    v_mfma_f32_16x16x32_bf16 v[144:147], v[64:67], v[108:111], v[144:147]
    ds_read_b64_tr_b16 v[60:61], v9 offset:24576
    v_mfma_f32_16x16x32_bf16 v[156:159], v[68:71], v[108:111], v[156:159]
    ds_read_b64_tr_b16 v[62:63], v9 offset:25600
    v_mfma_f32_16x16x32_bf16 v[156:159], v[36:39], v[96:99], v[156:159]
    ds_read_b64_tr_b16 v[28:29], v9 offset:16384
    v_mfma_f32_16x16x32_bf16 v[152:155], v[36:39], v[92:95], v[152:155]
    ds_read_b64_tr_b16 v[30:31], v9 offset:17408
    v_mfma_f32_16x16x32_bf16 v[152:155], v[68:71], v[104:107], v[152:155]
    ds_read_b64_tr_b16 v[32:33], v10 offset:16384
    v_mfma_f32_16x16x32_bf16 v[148:151], v[68:71], v[100:103], v[148:151]
    ds_read_b64_tr_b16 v[34:35], v10 offset:17408
    v_mfma_f32_16x16x32_bf16 v[148:151], v[36:39], v[88:91], v[148:151]
    ds_read_b64_tr_b16 v[64:65], v10 offset:24576
    v_mfma_f32_16x16x32_bf16 v[160:163], v[40:43], v[88:91], v[160:163]
    ds_read_b64_tr_b16 v[66:67], v10 offset:25600
    v_mfma_f32_16x16x32_bf16 v[160:163], v[72:75], v[100:103], v[160:163]
    ds_read_b64_tr_b16 v[68:69], v11 offset:24576
    v_mfma_f32_16x16x32_bf16 v[164:167], v[72:75], v[104:107], v[164:167]
    ds_read_b64_tr_b16 v[70:71], v11 offset:25600
    v_mfma_f32_16x16x32_bf16 v[164:167], v[40:43], v[92:95], v[164:167]
    ds_read_b64_tr_b16 v[36:37], v11 offset:16384
    v_mfma_f32_16x16x32_bf16 v[168:171], v[40:43], v[96:99], v[168:171]
    ds_read_b64_tr_b16 v[38:39], v11 offset:17408
    v_mfma_f32_16x16x32_bf16 v[168:171], v[72:75], v[108:111], v[168:171]
    ds_read_b64_tr_b16 v[40:41], v12 offset:16384
    v_mfma_f32_16x16x32_bf16 v[180:183], v[76:79], v[108:111], v[180:183]
    ds_read_b64_tr_b16 v[42:43], v12 offset:17408
    v_mfma_f32_16x16x32_bf16 v[180:183], v[44:47], v[96:99], v[180:183]
    ds_read_b64_tr_b16 v[72:73], v12 offset:24576
    v_mfma_f32_16x16x32_bf16 v[176:179], v[44:47], v[92:95], v[176:179]
    ds_read_b64_tr_b16 v[74:75], v12 offset:25600
    v_mfma_f32_16x16x32_bf16 v[176:179], v[76:79], v[104:107], v[176:179]
    ds_read_b128 v[208:211], v16 offset:24576
    v_mfma_f32_16x16x32_bf16 v[172:175], v[76:79], v[100:103], v[172:175]
    ds_read_b128 v[220:223], v17 offset:24576
    v_mfma_f32_16x16x32_bf16 v[172:175], v[44:47], v[88:91], v[172:175]
    ds_read_b64_tr_b16 v[76:77], v13 offset:24576
    v_mfma_f32_16x16x32_bf16 v[184:187], v[48:51], v[88:91], v[184:187]
    ds_read_b64_tr_b16 v[78:79], v13 offset:25600
    v_mfma_f32_16x16x32_bf16 v[184:187], v[80:83], v[100:103], v[184:187]
    ds_read_b64_tr_b16 v[44:45], v13 offset:16384
    v_mfma_f32_16x16x32_bf16 v[188:191], v[80:83], v[104:107], v[188:191]
    ds_read_b64_tr_b16 v[46:47], v13 offset:17408
    v_mfma_f32_16x16x32_bf16 v[188:191], v[48:51], v[92:95], v[188:191]
    ds_read_b128 v[224:227], v17 offset:26624
    v_mfma_f32_16x16x32_bf16 v[192:195], v[48:51], v[96:99], v[192:195]
    ds_read_b128 v[212:215], v16 offset:26624
    v_mfma_f32_16x16x32_bf16 v[192:195], v[80:83], v[108:111], v[192:195]
    ds_read_b64_tr_b16 v[48:49], v14 offset:16384
    v_mfma_f32_16x16x32_bf16 v[204:207], v[84:87], v[108:111], v[204:207]
    ds_read_b64_tr_b16 v[50:51], v14 offset:17408
    v_mfma_f32_16x16x32_bf16 v[204:207], v[52:55], v[96:99], v[204:207]
    ds_read_b64_tr_b16 v[80:81], v14 offset:24576
    v_mfma_f32_16x16x32_bf16 v[200:203], v[52:55], v[92:95], v[200:203]
    ds_read_b64_tr_b16 v[82:83], v14 offset:25600
    v_mfma_f32_16x16x32_bf16 v[200:203], v[84:87], v[104:107], v[200:203]
    ds_read_b128 v[216:219], v16 offset:28672
    v_mfma_f32_16x16x32_bf16 v[196:199], v[84:87], v[100:103], v[196:199]
    ds_read_b128 v[228:231], v17 offset:28672
    v_mfma_f32_16x16x32_bf16 v[196:199], v[52:55], v[88:91], v[196:199]
    s_waitcnt lgkmcnt(6)
    v_mfma_f32_16x16x32_bf16 v[112:115], v[24:27], v[208:211], v[112:115]
    ds_read_b64_tr_b16 v[84:85], v15 offset:24576
    v_mfma_f32_16x16x32_bf16 v[112:115], v[56:59], v[220:223], v[112:115]
    ds_read_b64_tr_b16 v[86:87], v15 offset:25600
    v_mfma_f32_16x16x32_bf16 v[116:119], v[56:59], v[224:227], v[116:119]
    ds_read_b64_tr_b16 v[52:53], v15 offset:16384
    v_mfma_f32_16x16x32_bf16 v[116:119], v[24:27], v[212:215], v[116:119]
    ds_read_b64_tr_b16 v[54:55], v15 offset:17408
    s_waitcnt lgkmcnt(5)
    v_mfma_f32_16x16x32_bf16 v[120:123], v[24:27], v[216:219], v[120:123]
    s_waitcnt lgkmcnt(4)
    v_mfma_f32_16x16x32_bf16 v[120:123], v[56:59], v[228:231], v[120:123]
    v_mfma_f32_16x16x32_bf16 v[132:135], v[60:63], v[228:231], v[132:135]
    v_mfma_f32_16x16x32_bf16 v[132:135], v[28:31], v[216:219], v[132:135]
    v_mfma_f32_16x16x32_bf16 v[128:131], v[28:31], v[212:215], v[128:131]
    v_mfma_f32_16x16x32_bf16 v[128:131], v[60:63], v[224:227], v[128:131]
    v_mfma_f32_16x16x32_bf16 v[124:127], v[60:63], v[220:223], v[124:127]
    v_mfma_f32_16x16x32_bf16 v[124:127], v[28:31], v[208:211], v[124:127]
    v_mfma_f32_16x16x32_bf16 v[136:139], v[32:35], v[208:211], v[136:139]
    v_mfma_f32_16x16x32_bf16 v[136:139], v[64:67], v[220:223], v[136:139]
    s_waitcnt lgkmcnt(0)
    s_barrier
    v_mfma_f32_16x16x32_bf16 v[140:143], v[64:67], v[224:227], v[140:143]
    ds_read_b64_tr_b16 v[24:25], v8 offset:32768
    ds_read_b64_tr_b16 v[26:27], v8 offset:33792
    v_mfma_f32_16x16x32_bf16 v[140:143], v[32:35], v[212:215], v[140:143]
    ds_read_b64_tr_b16 v[56:57], v8 offset:40960
    v_mfma_f32_16x16x32_bf16 v[144:147], v[32:35], v[216:219], v[144:147]
    ds_read_b64_tr_b16 v[58:59], v8 offset:41984
    v_mfma_f32_16x16x32_bf16 v[144:147], v[64:67], v[228:231], v[144:147]
    ds_read_b64_tr_b16 v[60:61], v9 offset:40960
    v_mfma_f32_16x16x32_bf16 v[156:159], v[68:71], v[228:231], v[156:159]
    ds_read_b64_tr_b16 v[62:63], v9 offset:41984
    v_mfma_f32_16x16x32_bf16 v[156:159], v[36:39], v[216:219], v[156:159]
    ds_read_b64_tr_b16 v[28:29], v9 offset:32768
    v_mfma_f32_16x16x32_bf16 v[152:155], v[36:39], v[212:215], v[152:155]
    ds_read_b64_tr_b16 v[30:31], v9 offset:33792
    v_mfma_f32_16x16x32_bf16 v[152:155], v[68:71], v[224:227], v[152:155]
    ds_read_b64_tr_b16 v[32:33], v10 offset:32768
    v_mfma_f32_16x16x32_bf16 v[148:151], v[68:71], v[220:223], v[148:151]
    ds_read_b64_tr_b16 v[34:35], v10 offset:33792
    v_mfma_f32_16x16x32_bf16 v[148:151], v[36:39], v[208:211], v[148:151]
    ds_read_b64_tr_b16 v[64:65], v10 offset:40960
    v_mfma_f32_16x16x32_bf16 v[160:163], v[40:43], v[208:211], v[160:163]
    ds_read_b64_tr_b16 v[66:67], v10 offset:41984
    v_mfma_f32_16x16x32_bf16 v[160:163], v[72:75], v[220:223], v[160:163]
    ds_read_b64_tr_b16 v[68:69], v11 offset:40960
    v_mfma_f32_16x16x32_bf16 v[164:167], v[72:75], v[224:227], v[164:167]
    ds_read_b64_tr_b16 v[70:71], v11 offset:41984
    v_mfma_f32_16x16x32_bf16 v[164:167], v[40:43], v[212:215], v[164:167]
    ds_read_b64_tr_b16 v[36:37], v11 offset:32768
    v_mfma_f32_16x16x32_bf16 v[168:171], v[40:43], v[216:219], v[168:171]
    ds_read_b64_tr_b16 v[38:39], v11 offset:33792
    v_mfma_f32_16x16x32_bf16 v[168:171], v[72:75], v[228:231], v[168:171]
    ds_read_b64_tr_b16 v[40:41], v12 offset:32768
    v_mfma_f32_16x16x32_bf16 v[180:183], v[76:79], v[228:231], v[180:183]
    ds_read_b64_tr_b16 v[42:43], v12 offset:33792
    v_mfma_f32_16x16x32_bf16 v[180:183], v[44:47], v[216:219], v[180:183]
    ds_read_b64_tr_b16 v[72:73], v12 offset:40960
    v_mfma_f32_16x16x32_bf16 v[176:179], v[44:47], v[212:215], v[176:179]
    ds_read_b64_tr_b16 v[74:75], v12 offset:41984
    v_mfma_f32_16x16x32_bf16 v[176:179], v[76:79], v[224:227], v[176:179]
    ds_read_b128 v[88:91], v16 offset:49152
    v_mfma_f32_16x16x32_bf16 v[172:175], v[76:79], v[220:223], v[172:175]
    ds_read_b128 v[100:103], v17 offset:49152
    v_mfma_f32_16x16x32_bf16 v[172:175], v[44:47], v[208:211], v[172:175]
    ds_read_b64_tr_b16 v[76:77], v13 offset:40960
    v_mfma_f32_16x16x32_bf16 v[184:187], v[48:51], v[208:211], v[184:187]
    ds_read_b64_tr_b16 v[78:79], v13 offset:41984
    v_mfma_f32_16x16x32_bf16 v[184:187], v[80:83], v[220:223], v[184:187]
    ds_read_b64_tr_b16 v[44:45], v13 offset:32768
    v_mfma_f32_16x16x32_bf16 v[188:191], v[80:83], v[224:227], v[188:191]
    ds_read_b64_tr_b16 v[46:47], v13 offset:33792
    v_mfma_f32_16x16x32_bf16 v[188:191], v[48:51], v[212:215], v[188:191]
    ds_read_b128 v[104:107], v17 offset:51200
    v_mfma_f32_16x16x32_bf16 v[192:195], v[48:51], v[216:219], v[192:195]
    ds_read_b128 v[92:95], v16 offset:51200
    v_mfma_f32_16x16x32_bf16 v[192:195], v[80:83], v[228:231], v[192:195]
    ds_read_b64_tr_b16 v[48:49], v14 offset:32768
    v_mfma_f32_16x16x32_bf16 v[204:207], v[84:87], v[228:231], v[204:207]
    ds_read_b64_tr_b16 v[50:51], v14 offset:33792
    v_mfma_f32_16x16x32_bf16 v[204:207], v[52:55], v[216:219], v[204:207]
    ds_read_b64_tr_b16 v[80:81], v14 offset:40960
    v_mfma_f32_16x16x32_bf16 v[200:203], v[52:55], v[212:215], v[200:203]
    ds_read_b64_tr_b16 v[82:83], v14 offset:41984
    v_mfma_f32_16x16x32_bf16 v[200:203], v[84:87], v[224:227], v[200:203]
    ds_read_b128 v[96:99], v16 offset:53248
    v_mfma_f32_16x16x32_bf16 v[196:199], v[84:87], v[220:223], v[196:199]
    ds_read_b128 v[108:111], v17 offset:53248
    v_mfma_f32_16x16x32_bf16 v[196:199], v[52:55], v[208:211], v[196:199]
    s_waitcnt lgkmcnt(6)
    v_mfma_f32_16x16x32_bf16 v[112:115], v[24:27], v[88:91], v[112:115]
    ds_read_b64_tr_b16 v[84:85], v15 offset:40960
    v_mfma_f32_16x16x32_bf16 v[112:115], v[56:59], v[100:103], v[112:115]
    ds_read_b64_tr_b16 v[86:87], v15 offset:41984
    v_mfma_f32_16x16x32_bf16 v[116:119], v[56:59], v[104:107], v[116:119]
    ds_read_b64_tr_b16 v[52:53], v15 offset:32768
    v_mfma_f32_16x16x32_bf16 v[116:119], v[24:27], v[92:95], v[116:119]
    ds_read_b64_tr_b16 v[54:55], v15 offset:33792
    s_waitcnt lgkmcnt(5)
    v_mfma_f32_16x16x32_bf16 v[120:123], v[24:27], v[96:99], v[120:123]
    s_waitcnt lgkmcnt(4)
    v_mfma_f32_16x16x32_bf16 v[120:123], v[56:59], v[108:111], v[120:123]
    v_mfma_f32_16x16x32_bf16 v[132:135], v[60:63], v[108:111], v[132:135]
    v_mfma_f32_16x16x32_bf16 v[132:135], v[28:31], v[96:99], v[132:135]
    v_mfma_f32_16x16x32_bf16 v[128:131], v[28:31], v[92:95], v[128:131]
    v_mfma_f32_16x16x32_bf16 v[128:131], v[60:63], v[104:107], v[128:131]
    v_mfma_f32_16x16x32_bf16 v[124:127], v[60:63], v[100:103], v[124:127]
    v_mfma_f32_16x16x32_bf16 v[124:127], v[28:31], v[88:91], v[124:127]
    v_mfma_f32_16x16x32_bf16 v[136:139], v[32:35], v[88:91], v[136:139]
    v_mfma_f32_16x16x32_bf16 v[136:139], v[64:67], v[100:103], v[136:139]
    s_waitcnt lgkmcnt(0)
    s_barrier
    v_mfma_f32_16x16x32_bf16 v[140:143], v[64:67], v[104:107], v[140:143]
    ds_read_b64_tr_b16 v[24:25], v8 offset:0
    ds_read_b64_tr_b16 v[26:27], v8 offset:1024
    v_mfma_f32_16x16x32_bf16 v[140:143], v[32:35], v[92:95], v[140:143]
    ds_read_b64_tr_b16 v[56:57], v8 offset:8192
    v_mfma_f32_16x16x32_bf16 v[144:147], v[32:35], v[96:99], v[144:147]
    ds_read_b64_tr_b16 v[58:59], v8 offset:9216
    v_mfma_f32_16x16x32_bf16 v[144:147], v[64:67], v[108:111], v[144:147]
    ds_read_b64_tr_b16 v[60:61], v9 offset:8192
    v_mfma_f32_16x16x32_bf16 v[156:159], v[68:71], v[108:111], v[156:159]
    ds_read_b64_tr_b16 v[62:63], v9 offset:9216
    v_mfma_f32_16x16x32_bf16 v[156:159], v[36:39], v[96:99], v[156:159]
    ds_read_b64_tr_b16 v[28:29], v9 offset:0
    v_mfma_f32_16x16x32_bf16 v[152:155], v[36:39], v[92:95], v[152:155]
    ds_read_b64_tr_b16 v[30:31], v9 offset:1024
    v_mfma_f32_16x16x32_bf16 v[152:155], v[68:71], v[104:107], v[152:155]
    ds_read_b64_tr_b16 v[32:33], v10 offset:0
    v_mfma_f32_16x16x32_bf16 v[148:151], v[68:71], v[100:103], v[148:151]
    ds_read_b64_tr_b16 v[34:35], v10 offset:1024
    v_mfma_f32_16x16x32_bf16 v[148:151], v[36:39], v[88:91], v[148:151]
    ds_read_b64_tr_b16 v[64:65], v10 offset:8192
    v_mfma_f32_16x16x32_bf16 v[160:163], v[40:43], v[88:91], v[160:163]
    ds_read_b64_tr_b16 v[66:67], v10 offset:9216
    v_mfma_f32_16x16x32_bf16 v[160:163], v[72:75], v[100:103], v[160:163]
    ds_read_b64_tr_b16 v[68:69], v11 offset:8192
    v_mfma_f32_16x16x32_bf16 v[164:167], v[72:75], v[104:107], v[164:167]
    ds_read_b64_tr_b16 v[70:71], v11 offset:9216
    v_mfma_f32_16x16x32_bf16 v[164:167], v[40:43], v[92:95], v[164:167]
    ds_read_b64_tr_b16 v[36:37], v11 offset:0
    v_mfma_f32_16x16x32_bf16 v[168:171], v[40:43], v[96:99], v[168:171]
    ds_read_b64_tr_b16 v[38:39], v11 offset:1024
    v_mfma_f32_16x16x32_bf16 v[168:171], v[72:75], v[108:111], v[168:171]
    ds_read_b64_tr_b16 v[40:41], v12 offset:0
    v_mfma_f32_16x16x32_bf16 v[180:183], v[76:79], v[108:111], v[180:183]
    ds_read_b64_tr_b16 v[42:43], v12 offset:1024
    v_mfma_f32_16x16x32_bf16 v[180:183], v[44:47], v[96:99], v[180:183]
    ds_read_b64_tr_b16 v[72:73], v12 offset:8192
    v_mfma_f32_16x16x32_bf16 v[176:179], v[44:47], v[92:95], v[176:179]
    ds_read_b64_tr_b16 v[74:75], v12 offset:9216
    v_mfma_f32_16x16x32_bf16 v[176:179], v[76:79], v[104:107], v[176:179]
    ds_read_b128 v[208:211], v16 offset:0
    v_mfma_f32_16x16x32_bf16 v[172:175], v[76:79], v[100:103], v[172:175]
    ds_read_b128 v[220:223], v17 offset:0
    v_mfma_f32_16x16x32_bf16 v[172:175], v[44:47], v[88:91], v[172:175]
    ds_read_b64_tr_b16 v[76:77], v13 offset:8192
    v_mfma_f32_16x16x32_bf16 v[184:187], v[48:51], v[88:91], v[184:187]
    ds_read_b64_tr_b16 v[78:79], v13 offset:9216
    v_mfma_f32_16x16x32_bf16 v[184:187], v[80:83], v[100:103], v[184:187]
    ds_read_b64_tr_b16 v[44:45], v13 offset:0
    v_mfma_f32_16x16x32_bf16 v[188:191], v[80:83], v[104:107], v[188:191]
    ds_read_b64_tr_b16 v[46:47], v13 offset:1024
    v_mfma_f32_16x16x32_bf16 v[188:191], v[48:51], v[92:95], v[188:191]
    ds_read_b128 v[224:227], v17 offset:2048
    v_mfma_f32_16x16x32_bf16 v[192:195], v[48:51], v[96:99], v[192:195]
    ds_read_b128 v[212:215], v16 offset:2048
    v_mfma_f32_16x16x32_bf16 v[192:195], v[80:83], v[108:111], v[192:195]
    ds_read_b64_tr_b16 v[48:49], v14 offset:0
    v_mfma_f32_16x16x32_bf16 v[204:207], v[84:87], v[108:111], v[204:207]
    ds_read_b64_tr_b16 v[50:51], v14 offset:1024
    v_mfma_f32_16x16x32_bf16 v[204:207], v[52:55], v[96:99], v[204:207]
    ds_read_b64_tr_b16 v[80:81], v14 offset:8192
    v_mfma_f32_16x16x32_bf16 v[200:203], v[52:55], v[92:95], v[200:203]
    ds_read_b64_tr_b16 v[82:83], v14 offset:9216
    v_mfma_f32_16x16x32_bf16 v[200:203], v[84:87], v[104:107], v[200:203]
    ds_read_b128 v[216:219], v16 offset:4096
    v_mfma_f32_16x16x32_bf16 v[196:199], v[84:87], v[100:103], v[196:199]
    ds_read_b128 v[228:231], v17 offset:4096
    v_mfma_f32_16x16x32_bf16 v[196:199], v[52:55], v[88:91], v[196:199]
    s_nop 0
    s_waitcnt lgkmcnt(6)
    v_mfma_f32_16x16x32_bf16 v[112:115], v[24:27], v[208:211], v[112:115]
    ds_read_b64_tr_b16 v[84:85], v15 offset:8192
    ds_read_b64_tr_b16 v[86:87], v15 offset:9216
    v_mfma_f32_16x16x32_bf16 v[112:115], v[56:59], v[220:223], v[112:115]
    ds_read_b64_tr_b16 v[52:53], v15 offset:0
    ds_read_b64_tr_b16 v[54:55], v15 offset:1024
    v_mfma_f32_16x16x32_bf16 v[124:127], v[60:63], v[220:223], v[124:127]
    v_add_u32 v8, v23, v8
    v_add_u32_e64 v9, v23, v9
    v_mfma_f32_16x16x32_bf16 v[124:127], v[28:31], v[208:211], v[124:127]
    v_add_u32 v10, v23, v10
    v_add_u32 v11, v23, v11
    v_mfma_f32_16x16x32_bf16 v[136:139], v[32:35], v[208:211], v[136:139]
    v_cvt_pk_bf16_f32 v112, v112, v113
    v_cvt_pk_bf16_f32 v113, v114, v115
    v_mfma_f32_16x16x32_bf16 v[136:139], v[64:67], v[220:223], v[136:139]
    v_add_u32 v12, v23, v12
    v_add_u32 v13, v23, v13
    v_mfma_f32_16x16x32_bf16 v[148:151], v[68:71], v[220:223], v[148:151]
    v_cvt_pk_bf16_f32 v114, v124, v125
    v_cvt_pk_bf16_f32 v115, v126, v127
    v_mfma_f32_16x16x32_bf16 v[148:151], v[36:39], v[208:211], v[148:151]
    v_add_u32 v14, v23, v14
    v_add_u32 v15, v23, v15
    v_mfma_f32_16x16x32_bf16 v[160:163], v[40:43], v[208:211], v[160:163]
    v_cvt_pk_bf16_f32 v136, v136, v137
    v_cvt_pk_bf16_f32 v137, v138, v139
    v_mfma_f32_16x16x32_bf16 v[160:163], v[72:75], v[220:223], v[160:163]
    s_waitcnt lgkmcnt(0)
    s_barrier
    v_mov_b32 v16, 0x3f803f80
    v_mfma_f32_16x16x32_bf16 v[172:175], v[76:79], v[220:223], v[172:175]
    v_cvt_pk_bf16_f32 v138, v148, v149
    ds_read_b64 v[88:89], v248 offset:24576
    v_mfma_f32_16x16x32_bf16 v[172:175], v[44:47], v[208:211], v[172:175]
    ds_read_b64 v[90:91], v249 offset:24576
    ds_read_b64 v[92:93], v250 offset:24576
    v_mfma_f32_16x16x32_bf16 v[184:187], v[48:51], v[208:211], v[184:187]
    ds_read_b64 v[94:95], v251 offset:24576
    ds_read_b64 v[96:97], v252 offset:24576
    v_mfma_f32_16x16x32_bf16 v[184:187], v[80:83], v[220:223], v[184:187]
    ds_read_b64 v[98:99], v253 offset:24576
    ds_read_b64 v[100:101], v254 offset:24576
    v_mfma_f32_16x16x32_bf16 v[196:199], v[84:87], v[220:223], v[196:199]
    ds_read_b64 v[102:103], v255 offset:24576
    ds_read_b64 v[104:105], v248 offset:32768
    v_mfma_f32_16x16x32_bf16 v[196:199], v[52:55], v[208:211], v[196:199]
    ds_read_b64 v[106:107], v249 offset:32768
    ds_read_b64 v[108:109], v250 offset:32768
    v_mfma_f32_16x16x32_bf16 v[200:203], v[52:55], v[212:215], v[200:203]
    ds_read_b64 v[110:111], v251 offset:32768
    ds_read_b64 v[232:233], v252 offset:32768
    v_mfma_f32_16x16x32_bf16 v[200:203], v[84:87], v[224:227], v[200:203]
    ds_read_b64 v[234:235], v253 offset:32768
    ds_read_b64 v[236:237], v254 offset:32768
    v_mfma_f32_16x16x32_bf16 v[188:191], v[80:83], v[224:227], v[188:191]
    ds_read_b64 v[238:239], v255 offset:32768
    ds_read_b64 v[240:241], v248 offset:40960
    v_mfma_f32_16x16x32_bf16 v[188:191], v[48:51], v[212:215], v[188:191]
    ds_read_b64 v[242:243], v249 offset:40960
    ds_read_b64 v[244:245], v250 offset:40960
    v_mfma_f32_16x16x32_bf16 v[176:179], v[44:47], v[212:215], v[176:179]
    ds_read_b64 v[246:247], v251 offset:40960
    s_waitcnt vmcnt(0)
    ds_read_b32 v2, v5 offset:16384
    v_mfma_f32_16x16x32_bf16 v[176:179], v[76:79], v[224:227], v[176:179]
    v_cvt_pk_bf16_f32 v139, v150, v151
    v_cvt_pk_bf16_f32 v160, v160, v161
    v_mfma_f32_16x16x32_bf16 v[164:167], v[72:75], v[224:227], v[164:167]
    v_cvt_pk_bf16_f32 v161, v162, v163
    v_cvt_pk_bf16_f32 v162, v172, v173
    v_mfma_f32_16x16x32_bf16 v[164:167], v[40:43], v[212:215], v[164:167]
    v_cvt_pk_bf16_f32 v163, v174, v175
    v_cvt_pk_bf16_f32 v184, v184, v185
    v_mfma_f32_16x16x32_bf16 v[152:155], v[36:39], v[212:215], v[152:155]
    v_cvt_pk_bf16_f32 v185, v186, v187
    v_cvt_pk_bf16_f32 v186, v196, v197
    v_mfma_f32_16x16x32_bf16 v[152:155], v[68:71], v[224:227], v[152:155]
    v_cvt_pk_bf16_f32 v187, v198, v199
    v_cvt_pk_bf16_f32 v188, v188, v189
    v_mfma_f32_16x16x32_bf16 v[140:143], v[64:67], v[224:227], v[140:143]
    v_cvt_pk_bf16_f32 v164, v164, v165
    v_cvt_pk_bf16_f32 v165, v166, v167
    v_mfma_f32_16x16x32_bf16 v[140:143], v[32:35], v[212:215], v[140:143]
    v_cvt_pk_bf16_f32 v166, v176, v177
    v_cvt_pk_bf16_f32 v167, v178, v179
    v_mfma_f32_16x16x32_bf16 v[128:131], v[28:31], v[212:215], v[128:131]
    v_cvt_pk_bf16_f32 v189, v190, v191
    s_waitcnt lgkmcnt(0)
    v_and_b32 v5, 0x2000, v2
    v_mfma_f32_16x16x32_bf16 v[128:131], v[60:63], v[224:227], v[128:131]
    v_xor_b32_e64 v21, v5, v21
    v_cvt_pk_bf16_f32 v190, v200, v201
    v_mfma_f32_16x16x32_bf16 v[116:119], v[56:59], v[224:227], v[116:119]
    v_cvt_pk_bf16_f32 v140, v140, v141
    v_cvt_pk_bf16_f32 v141, v142, v143
    v_mfma_f32_16x16x32_bf16 v[116:119], v[24:27], v[212:215], v[116:119]
    v_cvt_pk_bf16_f32 v142, v152, v153
    v_cvt_pk_bf16_f32 v143, v154, v155
    v_mfma_f32_16x16x32_bf16 v[120:123], v[24:27], v[216:219], v[120:123]
    ds_read_b64 v[24:25], v252 offset:40960
    ds_read_b64 v[26:27], v253 offset:40960
    v_mfma_f32_16x16x32_bf16 v[120:123], v[56:59], v[228:231], v[120:123]
    ds_read_b64 v[56:57], v254 offset:40960
    ds_read_b64 v[58:59], v255 offset:40960
    v_mfma_f32_16x16x32_bf16 v[132:135], v[60:63], v[228:231], v[132:135]
    ds_read_b64 v[60:61], v250 offset:49152
    ds_read_b64 v[62:63], v251 offset:49152
    v_mfma_f32_16x16x32_bf16 v[132:135], v[28:31], v[216:219], v[132:135]
    ds_read_b64 v[28:29], v248 offset:49152
    ds_read_b64 v[30:31], v249 offset:49152
    v_mfma_f32_16x16x32_bf16 v[144:147], v[32:35], v[216:219], v[144:147]
    ds_read_b64 v[32:33], v252 offset:49152
    ds_read_b64 v[34:35], v253 offset:49152
    v_mfma_f32_16x16x32_bf16 v[144:147], v[64:67], v[228:231], v[144:147]
    ds_read_b64 v[64:65], v254 offset:49152
    ds_read_b64 v[66:67], v255 offset:49152
    v_mfma_f32_16x16x32_bf16 v[156:159], v[68:71], v[228:231], v[156:159]
    ds_read_b64 v[68:69], v250 offset:57344
    ds_read_b64 v[70:71], v251 offset:57344
    v_mfma_f32_16x16x32_bf16 v[156:159], v[36:39], v[216:219], v[156:159]
    ds_read_b64 v[36:37], v248 offset:57344
    ds_read_b64 v[38:39], v249 offset:57344
    v_mfma_f32_16x16x32_bf16 v[168:171], v[40:43], v[216:219], v[168:171]
    ds_read_b64 v[40:41], v252 offset:57344
    ds_read_b64 v[42:43], v253 offset:57344
    v_mfma_f32_16x16x32_bf16 v[168:171], v[72:75], v[228:231], v[168:171]
    ds_read_b64 v[72:73], v254 offset:57344
    ds_read_b64 v[74:75], v255 offset:57344
    v_mfma_f32_16x16x32_bf16 v[180:183], v[76:79], v[228:231], v[180:183]
    ds_read_b64 v[76:77], v250 offset:0
    ds_read_b64 v[78:79], v251 offset:0
    v_mfma_f32_16x16x32_bf16 v[180:183], v[44:47], v[216:219], v[180:183]
    ds_read_b64 v[44:45], v248 offset:0
    ds_read_b64 v[46:47], v249 offset:0
    v_mfma_f32_16x16x32_bf16 v[192:195], v[48:51], v[216:219], v[192:195]
    ds_read_b64 v[48:49], v252 offset:0
    ds_read_b64 v[50:51], v253 offset:0
    v_mfma_f32_16x16x32_bf16 v[192:195], v[80:83], v[228:231], v[192:195]
    ds_read_b64 v[80:81], v254 offset:0
    ds_read_b64 v[82:83], v255 offset:0
    v_mfma_f32_16x16x32_bf16 v[204:207], v[84:87], v[228:231], v[204:207]
    v_cvt_pk_bf16_f32 v116, v116, v117
    v_cvt_pk_bf16_f32 v117, v118, v119
    v_mfma_f32_16x16x32_bf16 v[204:207], v[52:55], v[216:219], v[204:207]
    v_cvt_pk_bf16_f32 v118, v128, v129
    v_cvt_pk_bf16_f32 v119, v130, v131
    v_mfma_f32_16x16x32_bf16 v[208:211], v[88:91], v[112:115], 0
    v_cvt_pk_bf16_f32 v191, v202, v203
    v_cvt_pk_bf16_f32 v120, v120, v121
    v_mfma_f32_16x16x32_bf16 v[208:211], v[92:95], v[136:139], v[208:211]
    v_cvt_pk_bf16_f32 v121, v122, v123
    v_cvt_pk_bf16_f32 v122, v132, v133
    v_mfma_f32_16x16x32_bf16 v[208:211], v[96:99], v[160:163], v[208:211]
    v_cvt_pk_bf16_f32 v123, v134, v135
    v_cvt_pk_bf16_f32 v144, v144, v145
    v_mfma_f32_16x16x32_bf16 v[208:211], v[100:103], v[184:187], v[208:211]
    v_cvt_pk_bf16_f32 v145, v146, v147
    v_cvt_pk_bf16_f32 v146, v156, v157
    v_mfma_f32_16x16x32_bf16 v[220:223], v[104:107], v[112:115], 0
    v_cvt_pk_bf16_f32 v147, v158, v159
    v_cvt_pk_bf16_f32 v168, v168, v169
    v_mfma_f32_16x16x32_bf16 v[220:223], v[108:111], v[136:139], v[220:223]
    v_cvt_pk_bf16_f32 v169, v170, v171
    v_cvt_pk_bf16_f32 v170, v180, v181
    v_mfma_f32_16x16x32_bf16 v[220:223], v[232:235], v[160:163], v[220:223]
    v_cvt_pk_bf16_f32 v171, v182, v183
    v_cvt_pk_bf16_f32 v192, v192, v193
    v_mfma_f32_16x16x32_bf16 v[220:223], v[236:239], v[184:187], v[220:223]
    v_cvt_pk_bf16_f32 v193, v194, v195
    v_cvt_pk_bf16_f32 v194, v204, v205
    v_mfma_f32_16x16x32_bf16 v[212:215], v[240:243], v[112:115], 0
    v_cvt_pk_bf16_f32 v195, v206, v207
    v_mov_b32 v17, 0x3f803f80
    v_mfma_f32_16x16x32_bf16 v[212:215], v[244:247], v[136:139], v[212:215]
    v_mov_b32 v18, 0x3f803f80
    v_mov_b32 v19, 0x3f803f80
    s_waitcnt lgkmcnt(0)
    v_mfma_f32_16x16x32_bf16 v[212:215], v[24:27], v[160:163], v[212:215]
    v_mfma_f32_16x16x32_bf16 v[212:215], v[56:59], v[184:187], v[212:215]
    v_mfma_f32_16x16x32_bf16 v[224:227], v[28:31], v[112:115], 0
    v_mfma_f32_16x16x32_bf16 v[224:227], v[60:63], v[136:139], v[224:227]
    v_mfma_f32_16x16x32_bf16 v[224:227], v[32:35], v[160:163], v[224:227]
    v_mfma_f32_16x16x32_bf16 v[224:227], v[64:67], v[184:187], v[224:227]
    v_mfma_f32_16x16x32_bf16 v[52:55], v[36:39], v[112:115], 0
    v_mfma_f32_16x16x32_bf16 v[52:55], v[68:71], v[136:139], v[52:55]
    v_mfma_f32_16x16x32_bf16 v[52:55], v[40:43], v[160:163], v[52:55]
    v_mfma_f32_16x16x32_bf16 v[52:55], v[72:75], v[184:187], v[52:55]
    v_mfma_f32_16x16x32_bf16 v[84:87], v[44:47], v[112:115], 0
    v_mfma_f32_16x16x32_bf16 v[84:87], v[76:79], v[136:139], v[84:87]
    v_mfma_f32_16x16x32_bf16 v[84:87], v[48:51], v[160:163], v[84:87]
    v_mfma_f32_16x16x32_bf16 v[84:87], v[80:83], v[184:187], v[84:87]
    v_max3_f32 v184, v208, v209, v210
    v_max3_f32 v186, v211, v220, v221
    v_mfma_f32_16x16x32_bf16 v[124:127], v[88:91], v[116:119], 0
    v_max3_f32 v184, v184, v222, v223
    v_max3_f32 v186, v186, v212, v213
    v_mfma_f32_16x16x32_bf16 v[124:127], v[92:95], v[140:143], v[124:127]
    v_max3_f32 v184, v184, v214, v215
    v_max3_f32 v186, v186, v224, v225
    v_mfma_f32_16x16x32_bf16 v[124:127], v[96:99], v[164:167], v[124:127]
    v_max3_f32 v184, v184, v226, v227
    v_max3_f32 v186, v186, v52, v53
    v_mfma_f32_16x16x32_bf16 v[124:127], v[100:103], v[188:191], v[124:127]
    v_max3_f32 v184, v184, v54, v55
    v_max3_f32 v186, v186, v84, v85
    v_mfma_f32_16x16x32_bf16 v[148:151], v[104:107], v[116:119], 0
    v_max3_f32 v184, v184, v86, v87
    v_max_f32 v187, v184, v186
    v_mfma_f32_16x16x32_bf16 v[148:151], v[108:111], v[140:143], v[148:151]
    v_max_f32_e64 v184, v184, v186
    v_mfma_f32_16x16x32_bf16 v[148:151], v[232:235], v[164:167], v[148:151]
    s_nop 0
    v_permlane16_swap_b32 v187, v184
    v_max_f32_e64 v186, v184, v187
    v_mfma_f32_16x16x32_bf16 v[148:151], v[236:239], v[188:191], v[148:151]
    v_max_f32_e64 v184, v184, v187
    v_mfma_f32_16x16x32_bf16 v[172:175], v[240:243], v[116:119], 0
    s_nop 0
    v_permlane32_swap_b32 v186, v184
    v_max_f32_e64 v184, v184, v186
    v_mfma_f32_16x16x32_bf16 v[172:175], v[244:247], v[140:143], v[172:175]
    v_mul_f32_e64 v184, s82, v184
    v_pk_fma_f32 v[208:209], v[208:209], s[80:81], v[184:185] op_sel_hi:[1,1,0]
    v_pk_fma_f32 v[210:211], v[210:211], s[80:81], v[184:185] op_sel_hi:[1,1,0]
    v_pk_fma_f32 v[220:221], v[220:221], s[80:81], v[184:185] op_sel_hi:[1,1,0]
    v_pk_fma_f32 v[222:223], v[222:223], s[80:81], v[184:185] op_sel_hi:[1,1,0]
    v_pk_fma_f32 v[212:213], v[212:213], s[80:81], v[184:185] op_sel_hi:[1,1,0]
    v_pk_fma_f32 v[214:215], v[214:215], s[80:81], v[184:185] op_sel_hi:[1,1,0]
    v_pk_fma_f32 v[224:225], v[224:225], s[80:81], v[184:185] op_sel_hi:[1,1,0]
    v_pk_fma_f32 v[226:227], v[226:227], s[80:81], v[184:185] op_sel_hi:[1,1,0]
    v_pk_fma_f32 v[52:53], v[52:53], s[80:81], v[184:185] op_sel_hi:[1,1,0]
    v_pk_fma_f32 v[54:55], v[54:55], s[80:81], v[184:185] op_sel_hi:[1,1,0]
    v_pk_fma_f32 v[84:85], v[84:85], s[80:81], v[184:185] op_sel_hi:[1,1,0]
    v_pk_fma_f32 v[86:87], v[86:87], s[80:81], v[184:185] op_sel_hi:[1,1,0]
    v_exp_f32_e64 v208, v208
    v_mfma_f32_16x16x32_bf16 v[172:175], v[24:27], v[164:167], v[172:175]
    v_exp_f32_e64 v209, v209
    v_mfma_f32_16x16x32_bf16 v[172:175], v[56:59], v[188:191], v[172:175]
    v_exp_f32_e64 v210, v210
    v_mfma_f32_16x16x32_bf16 v[196:199], v[28:31], v[116:119], 0
    v_exp_f32_e64 v211, v211
    v_mfma_f32_16x16x32_bf16 v[196:199], v[60:63], v[140:143], v[196:199]
    v_cvt_pk_bf16_f32 v112, v208, v209
    v_cvt_pk_bf16_f32 v113, v210, v211
    v_mfma_f32_16x16x32_bf16 v[196:199], v[32:35], v[164:167], v[196:199]
    v_exp_f32_e64 v220, v220
    v_mfma_f32_16x16x32_bf16 v[196:199], v[64:67], v[188:191], v[196:199]
    v_exp_f32_e64 v221, v221
    v_mfma_f32_16x16x32_bf16 v[128:131], v[36:39], v[116:119], 0
    v_exp_f32_e64 v222, v222
    v_mfma_f32_16x16x32_bf16 v[128:131], v[68:71], v[140:143], v[128:131]
    v_exp_f32_e64 v223, v223
    v_mfma_f32_16x16x32_bf16 v[128:131], v[40:43], v[164:167], v[128:131]
    v_cvt_pk_bf16_f32 v114, v220, v221
    v_cvt_pk_bf16_f32 v115, v222, v223
    v_mfma_f32_16x16x32_bf16 v[128:131], v[72:75], v[188:191], v[128:131]
    v_exp_f32_e64 v212, v212
    v_mfma_f32_16x16x32_bf16 v[152:155], v[44:47], v[116:119], 0
    v_exp_f32_e64 v213, v213
    v_mfma_f32_16x16x32_bf16 v[152:155], v[76:79], v[140:143], v[152:155]
    v_exp_f32_e64 v214, v214
    v_mfma_f32_16x16x32_bf16 v[152:155], v[48:51], v[164:167], v[152:155]
    v_exp_f32_e64 v215, v215
    v_mfma_f32_16x16x32_bf16 v[152:155], v[80:83], v[188:191], v[152:155]
    v_cvt_pk_bf16_f32 v136, v212, v213
    v_cvt_pk_bf16_f32 v137, v214, v215
    v_mfma_f32_16x16x32_bf16 v[176:179], v[88:91], v[120:123], 0
    v_exp_f32_e64 v224, v224
    v_mfma_f32_16x16x32_bf16 v[176:179], v[92:95], v[144:147], v[176:179]
    v_exp_f32_e64 v225, v225
    v_mfma_f32_16x16x32_bf16 v[176:179], v[96:99], v[168:171], v[176:179]
    v_exp_f32_e64 v226, v226
    v_mfma_f32_16x16x32_bf16 v[176:179], v[100:103], v[192:195], v[176:179]
    v_exp_f32_e64 v227, v227
    v_mfma_f32_16x16x32_bf16 v[200:203], v[104:107], v[120:123], 0
    v_cvt_pk_bf16_f32 v138, v224, v225
    v_cvt_pk_bf16_f32 v139, v226, v227
    v_mfma_f32_16x16x32_bf16 v[200:203], v[108:111], v[144:147], v[200:203]
    v_exp_f32_e64 v52, v52
    v_mfma_f32_16x16x32_bf16 v[200:203], v[232:235], v[168:171], v[200:203]
    v_exp_f32_e64 v53, v53
    v_mfma_f32_16x16x32_bf16 v[200:203], v[236:239], v[192:195], v[200:203]
    v_exp_f32_e64 v54, v54
    v_mfma_f32_16x16x32_bf16 v[132:135], v[240:243], v[120:123], 0
    v_exp_f32_e64 v55, v55
    v_mfma_f32_16x16x32_bf16 v[132:135], v[244:247], v[144:147], v[132:135]
    v_cvt_pk_bf16_f32 v160, v52, v53
    v_cvt_pk_bf16_f32 v161, v54, v55
    v_mfma_f32_16x16x32_bf16 v[132:135], v[24:27], v[168:171], v[132:135]
    v_exp_f32_e64 v84, v84
    v_mfma_f32_16x16x32_bf16 v[132:135], v[56:59], v[192:195], v[132:135]
    v_exp_f32_e64 v85, v85
    v_mfma_f32_16x16x32_bf16 v[156:159], v[28:31], v[120:123], 0
    v_exp_f32_e64 v86, v86
    v_mfma_f32_16x16x32_bf16 v[156:159], v[60:63], v[144:147], v[156:159]
    v_exp_f32_e64 v87, v87
    v_mfma_f32_16x16x32_bf16 v[156:159], v[32:35], v[168:171], v[156:159]
    v_cvt_pk_bf16_f32 v162, v84, v85
    v_cvt_pk_bf16_f32 v163, v86, v87
    v_mfma_f32_16x16x32_bf16 v[156:159], v[64:67], v[192:195], v[156:159]
    v_max3_f32 v188, v124, v125, v126
    v_max3_f32 v190, v127, v148, v149
    v_mfma_f32_16x16x32_bf16 v[180:183], v[36:39], v[120:123], 0
    v_max3_f32 v188, v188, v150, v151
    v_max3_f32 v190, v190, v172, v173
    v_mfma_f32_16x16x32_bf16 v[180:183], v[68:71], v[144:147], v[180:183]
    v_max3_f32 v188, v188, v174, v175
    v_max3_f32 v190, v190, v196, v197
    v_mfma_f32_16x16x32_bf16 v[180:183], v[40:43], v[168:171], v[180:183]
    v_max3_f32 v188, v188, v198, v199
    v_max3_f32 v190, v190, v128, v129
    v_mfma_f32_16x16x32_bf16 v[180:183], v[72:75], v[192:195], v[180:183]
    v_max3_f32 v188, v188, v130, v131
    v_max3_f32 v190, v190, v152, v153
    v_mfma_f32_16x16x32_bf16 v[204:207], v[44:47], v[120:123], 0
    v_max3_f32 v188, v188, v154, v155
    v_max_f32_e64 v191, v188, v190
    v_mfma_f32_16x16x32_bf16 v[204:207], v[76:79], v[144:147], v[204:207]
    v_max_f32_e64 v188, v188, v190
    v_mfma_f32_16x16x32_bf16 v[204:207], v[48:51], v[168:171], v[204:207]
    s_nop 0
    v_permlane16_swap_b32 v191, v188
    v_max_f32_e64 v190, v188, v191
    v_mfma_f32_16x16x32_bf16 v[204:207], v[80:83], v[192:195], v[204:207]
    v_max_f32_e64 v188, v188, v191
    v_max3_f32 v192, v176, v177, v178
    v_mfma_f32_16x16x32_bf16 v[184:187], v[16:19], v[112:115], 0
    v_permlane32_swap_b32 v190, v188
    v_max3_f32 v194, v179, v200, v201
    v_mfma_f32_16x16x32_bf16 v[184:187], v[16:19], v[136:139], v[184:187]
    v_max_f32 v188, v188, v190
    v_max3_f32 v192, v192, v202, v203
    v_mfma_f32_16x16x32_bf16 v[184:187], v[16:19], v[160:163], v[184:187]
    v_mul_f32_e64 v188, s82, v188
    v_max3_f32 v194, v194, v132, v133
    v_max3_f32 v192, v192, v134, v135
    v_max3_f32 v194, v194, v156, v157
    v_max3_f32 v192, v192, v158, v159
    v_pk_fma_f32 v[124:125], v[124:125], s[80:81], v[188:189] op_sel_hi:[1,1,0]
    v_pk_fma_f32 v[126:127], v[126:127], s[80:81], v[188:189] op_sel_hi:[1,1,0]
    v_pk_fma_f32 v[148:149], v[148:149], s[80:81], v[188:189] op_sel_hi:[1,1,0]
    v_pk_fma_f32 v[150:151], v[150:151], s[80:81], v[188:189] op_sel_hi:[1,1,0]
    v_pk_fma_f32 v[172:173], v[172:173], s[80:81], v[188:189] op_sel_hi:[1,1,0]
    v_pk_fma_f32 v[174:175], v[174:175], s[80:81], v[188:189] op_sel_hi:[1,1,0]
    v_pk_fma_f32 v[196:197], v[196:197], s[80:81], v[188:189] op_sel_hi:[1,1,0]
    v_pk_fma_f32 v[198:199], v[198:199], s[80:81], v[188:189] op_sel_hi:[1,1,0]
    v_pk_fma_f32 v[128:129], v[128:129], s[80:81], v[188:189] op_sel_hi:[1,1,0]
    v_pk_fma_f32 v[130:131], v[130:131], s[80:81], v[188:189] op_sel_hi:[1,1,0]
    v_pk_fma_f32 v[152:153], v[152:153], s[80:81], v[188:189] op_sel_hi:[1,1,0]
    v_pk_fma_f32 v[154:155], v[154:155], s[80:81], v[188:189] op_sel_hi:[1,1,0]
    v_rcp_f32 v184, v184
    v_exp_f32 v124, v124
    v_exp_f32 v125, v125
    v_exp_f32 v126, v126
    v_exp_f32_e64 v127, v127
    v_cvt_pk_bf16_f32 v116, v124, v125
    v_exp_f32_e64 v148, v148
    v_cvt_pk_bf16_f32 v117, v126, v127
    v_exp_f32 v149, v149
    v_exp_f32 v150, v150
    v_exp_f32_e64 v151, v151
    v_cvt_pk_bf16_f32 v118, v148, v149
    v_exp_f32_e64 v172, v172
    v_cvt_pk_bf16_f32 v119, v150, v151
    v_exp_f32 v173, v173
    s_nop 0
    v_mfma_f32_16x16x32_bf16 v[188:191], v[16:19], v[116:119], 0
    s_barrier
    v_exp_f32 v174, v174
    v_exp_f32_e64 v175, v175
    ds_read_b64_tr_b16 v[88:89], v8 offset:0
    ds_read_b64_tr_b16 v[90:91], v8 offset:4096
    ds_read_b64_tr_b16 v[92:93], v8 offset:8192
    ds_read_b64_tr_b16 v[94:95], v8 offset:12288
    ds_read_b64_tr_b16 v[96:97], v8 offset:16384
    v_cvt_pk_bf16_f32 v140, v172, v173
    ds_read_b64_tr_b16 v[98:99], v8 offset:20480
    v_cvt_pk_bf16_f32 v141, v174, v175
    ds_read_b64_tr_b16 v[100:101], v9 offset:0
    v_exp_f32_e64 v196, v196
    ds_read_b64_tr_b16 v[102:103], v9 offset:4096
    ds_read_b64_tr_b16 v[104:105], v9 offset:8192
    ds_read_b64_tr_b16 v[106:107], v9 offset:12288
    v_exp_f32_e64 v197, v197
    ds_read_b64_tr_b16 v[108:109], v9 offset:16384
    ds_read_b64_tr_b16 v[110:111], v9 offset:20480
    v_exp_f32_e64 v198, v198
    ds_read_b64_tr_b16 v[232:233], v10 offset:0
    ds_read_b64_tr_b16 v[234:235], v10 offset:4096
    v_exp_f32_e64 v199, v199
    ds_read_b64_tr_b16 v[236:237], v10 offset:8192
    ds_read_b64_tr_b16 v[238:239], v10 offset:12288
    ds_read_b64_tr_b16 v[240:241], v10 offset:16384
    v_cvt_pk_bf16_f32 v142, v196, v197
    ds_read_b64_tr_b16 v[242:243], v10 offset:20480
    v_cvt_pk_bf16_f32 v143, v198, v199
    ds_read_b64_tr_b16 v[244:245], v11 offset:0
    s_waitcnt lgkmcnt(9)
    v_mfma_f32_16x16x32_bf16 v[208:211], v[88:91], v[112:115], 0
    ds_read_b64_tr_b16 v[246:247], v11 offset:4096
    ds_read_b64_tr_b16 v[24:25], v11 offset:8192
    v_mfma_f32_16x16x32_bf16 v[208:211], v[92:95], v[136:139], v[208:211]
    ds_read_b64_tr_b16 v[26:27], v11 offset:12288
    ds_read_b64_tr_b16 v[56:57], v11 offset:16384
    v_mfma_f32_16x16x32_bf16 v[208:211], v[96:99], v[160:163], v[208:211]
    ds_read_b64_tr_b16 v[58:59], v11 offset:20480
    ds_read_b64_tr_b16 v[28:29], v12 offset:0
    v_mfma_f32_16x16x32_bf16 v[220:223], v[100:103], v[112:115], 0
    ds_read_b64_tr_b16 v[30:31], v12 offset:4096
    ds_read_b64_tr_b16 v[60:61], v12 offset:8192
    v_mfma_f32_16x16x32_bf16 v[220:223], v[104:107], v[136:139], v[220:223]
    ds_read_b64_tr_b16 v[62:63], v12 offset:12288
    ds_read_b64_tr_b16 v[32:33], v12 offset:16384
    s_waitcnt lgkmcnt(9)
    v_mfma_f32_16x16x32_bf16 v[220:223], v[108:111], v[160:163], v[220:223]
    ds_read_b64_tr_b16 v[34:35], v12 offset:20480
    ds_read_b64_tr_b16 v[64:65], v13 offset:0
    v_mfma_f32_16x16x32_bf16 v[212:215], v[232:235], v[112:115], 0
    ds_read_b64_tr_b16 v[66:67], v13 offset:4096
    ds_read_b64_tr_b16 v[36:37], v13 offset:8192
    ds_read_b64_tr_b16 v[38:39], v13 offset:12288
    ds_read_b64_tr_b16 v[68:69], v13 offset:16384
    v_exp_f32_e64 v128, v128
    v_pk_mul_f32 v[208:209], v[208:209], v[184:185] op_sel_hi:[1,0]
    v_pk_mul_f32 v[210:211], v[210:211], v[184:185] op_sel_hi:[1,0]
    v_pk_mul_f32 v[220:221], v[220:221], v[184:185] op_sel_hi:[1,0]
    v_pk_mul_f32 v[222:223], v[222:223], v[184:185] op_sel_hi:[1,0]
    ds_read_b64_tr_b16 v[70:71], v13 offset:20480
    v_mfma_f32_16x16x32_bf16 v[212:215], v[236:239], v[136:139], v[212:215]
    ds_read_b64_tr_b16 v[40:41], v14 offset:0
    ds_read_b64_tr_b16 v[42:43], v14 offset:4096
    v_mfma_f32_16x16x32_bf16 v[212:215], v[240:243], v[160:163], v[212:215]
    ds_read_b64_tr_b16 v[72:73], v14 offset:8192
    ds_read_b64_tr_b16 v[74:75], v14 offset:12288
    v_mfma_f32_16x16x32_bf16 v[224:227], v[244:247], v[112:115], 0
    ds_read_b64_tr_b16 v[44:45], v14 offset:16384
    ds_read_b64_tr_b16 v[46:47], v14 offset:20480
    s_waitcnt lgkmcnt(7)
    v_mfma_f32_16x16x32_bf16 v[224:227], v[24:27], v[136:139], v[224:227]
    ds_read_b64_tr_b16 v[76:77], v15 offset:0
    ds_read_b64_tr_b16 v[78:79], v15 offset:4096
    v_mfma_f32_16x16x32_bf16 v[224:227], v[56:59], v[160:163], v[224:227]
    ds_read_b64_tr_b16 v[48:49], v15 offset:8192
    ds_read_b64_tr_b16 v[50:51], v15 offset:12288
    v_mfma_f32_16x16x32_bf16 v[52:55], v[28:31], v[112:115], 0
    ds_read_b64_tr_b16 v[80:81], v15 offset:16384
    ds_read_b64_tr_b16 v[82:83], v15 offset:20480
    v_cvt_pk_bf16_f32 v208, v208, v209
    v_cvt_pk_bf16_f32 v209, v210, v211
    v_cvt_pk_bf16_f32 v210, v220, v221
    v_pk_mul_f32 v[212:213], v[212:213], v[184:185] op_sel_hi:[1,0]
    v_pk_mul_f32 v[214:215], v[214:215], v[184:185] op_sel_hi:[1,0]
    v_pk_mul_f32 v[224:225], v[224:225], v[184:185] op_sel_hi:[1,0]
    v_pk_mul_f32 v[226:227], v[226:227], v[184:185] op_sel_hi:[1,0]
    v_cvt_pk_bf16_f32 v211, v222, v223
    v_mfma_f32_16x16x32_bf16 v[52:55], v[60:63], v[136:139], v[52:55]
    buffer_store_dwordx4 v[208:211], v21, s[56:59], s48 offen sc1
    v_mfma_f32_16x16x32_bf16 v[52:55], v[32:35], v[160:163], v[52:55]
    v_cvt_pk_bf16_f32 v212, v212, v213
    v_cvt_pk_bf16_f32 v213, v214, v215
    v_mfma_f32_16x16x32_bf16 v[84:87], v[64:67], v[112:115], 0
    v_cvt_pk_bf16_f32 v214, v224, v225
    v_cvt_pk_bf16_f32 v215, v226, v227
    v_mfma_f32_16x16x32_bf16 v[84:87], v[36:39], v[136:139], v[84:87]
    buffer_store_dwordx4 v[212:215], v21, s[56:59], s51 offen sc1
    s_waitcnt lgkmcnt(0)
    v_mfma_f32_16x16x32_bf16 v[84:87], v[68:71], v[160:163], v[84:87]
    v_exp_f32_e64 v129, v129
    v_mfma_f32_16x16x32_bf16 v[216:219], v[40:43], v[112:115], 0
    v_exp_f32 v130, v130
    v_exp_f32 v131, v131
    v_cvt_pk_bf16_f32 v164, v128, v129
    v_pk_mul_f32 v[52:53], v[52:53], v[184:185] op_sel_hi:[1,0]
    v_pk_mul_f32 v[54:55], v[54:55], v[184:185] op_sel_hi:[1,0]
    s_nop 0
    v_pk_mul_f32 v[84:85], v[84:85], v[184:185] op_sel_hi:[1,0]
    v_pk_mul_f32 v[86:87], v[86:87], v[184:185] op_sel_hi:[1,0]
    v_cvt_pk_bf16_f32 v52, v52, v53
    v_mfma_f32_16x16x32_bf16 v[216:219], v[72:75], v[136:139], v[216:219]
    v_cvt_pk_bf16_f32 v53, v54, v55
    v_cvt_pk_bf16_f32 v54, v84, v85
    v_mfma_f32_16x16x32_bf16 v[216:219], v[44:47], v[160:163], v[216:219]
    v_cvt_pk_bf16_f32 v55, v86, v87
    v_cvt_pk_bf16_f32 v165, v130, v131
    v_mfma_f32_16x16x32_bf16 v[228:231], v[76:79], v[112:115], 0
    buffer_store_dwordx4 v[52:55], v21, s[56:59], s54 offen sc1
    v_mfma_f32_16x16x32_bf16 v[228:231], v[48:51], v[136:139], v[228:231]
    v_exp_f32 v152, v152
    v_mfma_f32_16x16x32_bf16 v[228:231], v[80:83], v[160:163], v[228:231]
    v_exp_f32_e64 v153, v153
    v_mfma_f32_16x16x32_bf16 v[188:191], v[16:19], v[140:143], v[188:191]
    v_exp_f32 v154, v154
    v_exp_f32 v155, v155
    v_cvt_pk_bf16_f32 v166, v152, v153
    v_pk_mul_f32 v[216:217], v[216:217], v[184:185] op_sel_hi:[1,0]
    v_pk_mul_f32 v[218:219], v[218:219], v[184:185] op_sel_hi:[1,0]
    s_nop 0
    v_pk_mul_f32 v[228:229], v[228:229], v[184:185] op_sel_hi:[1,0]
    v_pk_mul_f32 v[230:231], v[230:231], v[184:185] op_sel_hi:[1,0]
    v_cvt_pk_bf16_f32 v216, v216, v217
    v_mfma_f32_16x16x32_bf16 v[124:127], v[88:91], v[116:119], 0
    v_cvt_pk_bf16_f32 v217, v218, v219
    v_cvt_pk_bf16_f32 v218, v228, v229
    v_mfma_f32_16x16x32_bf16 v[124:127], v[92:95], v[140:143], v[124:127]
    v_cvt_pk_bf16_f32 v219, v230, v231
    v_cvt_pk_bf16_f32 v167, v154, v155
    v_mfma_f32_16x16x32_bf16 v[148:151], v[100:103], v[116:119], 0
    buffer_store_dwordx4 v[216:219], v21, s[56:59], s61 offen sc1
    v_mfma_f32_16x16x32_bf16 v[188:191], v[16:19], v[164:167], v[188:191]
    v_max3_f32 v194, v194, v180, v181
    v_max3_f32 v192, v192, v182, v183
    v_mfma_f32_16x16x32_bf16 v[124:127], v[96:99], v[164:167], v[124:127]
    v_max3_f32 v194, v194, v204, v205
    v_max3_f32 v192, v192, v206, v207
    v_mfma_f32_16x16x32_bf16 v[148:151], v[104:107], v[140:143], v[148:151]
    v_max_f32 v195, v192, v194
    v_max_f32_e64 v192, v192, v194
    v_mfma_f32_16x16x32_bf16 v[148:151], v[108:111], v[164:167], v[148:151]
    v_rcp_f32_e64 v188, v188
    v_mfma_f32_16x16x32_bf16 v[172:175], v[232:235], v[116:119], 0
    v_permlane16_swap_b32 v195, v192
    v_max_f32 v194, v192, v195
    v_max_f32_e64 v192, v192, v195
    v_pk_mul_f32 v[124:125], v[124:125], v[188:189] op_sel_hi:[1,0]
    v_pk_mul_f32 v[126:127], v[126:127], v[188:189] op_sel_hi:[1,0]
    s_nop 0
    v_pk_mul_f32 v[148:149], v[148:149], v[188:189] op_sel_hi:[1,0]
    v_pk_mul_f32 v[150:151], v[150:151], v[188:189] op_sel_hi:[1,0]
    v_cvt_pk_bf16_f32 v124, v124, v125
    v_mfma_f32_16x16x32_bf16 v[172:175], v[236:239], v[140:143], v[172:175]
    v_cvt_pk_bf16_f32 v125, v126, v127
    v_cvt_pk_bf16_f32 v126, v148, v149
    v_mfma_f32_16x16x32_bf16 v[172:175], v[240:243], v[164:167], v[172:175]
    v_cvt_pk_bf16_f32 v127, v150, v151
    v_permlane32_swap_b32 v194, v192
    v_mfma_f32_16x16x32_bf16 v[196:199], v[244:247], v[116:119], 0
    buffer_store_dwordx4 v[124:127], v21, s[56:59], s49 offen sc1
    v_mfma_f32_16x16x32_bf16 v[196:199], v[24:27], v[140:143], v[196:199]
    v_max_f32 v192, v192, v194
    v_mul_f32_e64 v192, s82, v192
    s_nop 0
    v_pk_mul_f32 v[172:173], v[172:173], v[188:189] op_sel_hi:[1,0]
    v_pk_mul_f32 v[174:175], v[174:175], v[188:189] op_sel_hi:[1,0]
    v_pk_fma_f32 v[176:177], v[176:177], s[80:81], v[192:193] op_sel_hi:[1,1,0]
    v_pk_fma_f32 v[178:179], v[178:179], s[80:81], v[192:193] op_sel_hi:[1,1,0]
    v_pk_fma_f32 v[200:201], v[200:201], s[80:81], v[192:193] op_sel_hi:[1,1,0]
    v_pk_fma_f32 v[202:203], v[202:203], s[80:81], v[192:193] op_sel_hi:[1,1,0]
    v_pk_fma_f32 v[132:133], v[132:133], s[80:81], v[192:193] op_sel_hi:[1,1,0]
    v_pk_fma_f32 v[134:135], v[134:135], s[80:81], v[192:193] op_sel_hi:[1,1,0]
    v_pk_fma_f32 v[156:157], v[156:157], s[80:81], v[192:193] op_sel_hi:[1,1,0]
    v_pk_fma_f32 v[158:159], v[158:159], s[80:81], v[192:193] op_sel_hi:[1,1,0]
    v_pk_fma_f32 v[180:181], v[180:181], s[80:81], v[192:193] op_sel_hi:[1,1,0]
    v_pk_fma_f32 v[182:183], v[182:183], s[80:81], v[192:193] op_sel_hi:[1,1,0]
    v_pk_fma_f32 v[204:205], v[204:205], s[80:81], v[192:193] op_sel_hi:[1,1,0]
    v_pk_fma_f32 v[206:207], v[206:207], s[80:81], v[192:193] op_sel_hi:[1,1,0]
    v_cvt_pk_bf16_f32 v172, v172, v173
    v_mfma_f32_16x16x32_bf16 v[196:199], v[56:59], v[164:167], v[196:199]
    v_cvt_pk_bf16_f32 v173, v174, v175
    v_exp_f32_e64 v176, v176
    v_mfma_f32_16x16x32_bf16 v[128:131], v[28:31], v[116:119], 0
    v_exp_f32_e64 v177, v177
    v_mfma_f32_16x16x32_bf16 v[128:131], v[60:63], v[140:143], v[128:131]
    v_exp_f32_e64 v178, v178
    v_mfma_f32_16x16x32_bf16 v[128:131], v[32:35], v[164:167], v[128:131]
    v_exp_f32_e64 v179, v179
    v_mfma_f32_16x16x32_bf16 v[152:155], v[64:67], v[116:119], 0
    v_cvt_pk_bf16_f32 v120, v176, v177
    v_cvt_pk_bf16_f32 v121, v178, v179
    v_exp_f32 v200, v200
    v_exp_f32 v201, v201
    v_pk_mul_f32 v[196:197], v[196:197], v[188:189] op_sel_hi:[1,0]
    v_pk_mul_f32 v[198:199], v[198:199], v[188:189] op_sel_hi:[1,0]
    v_pk_mul_f32 v[128:129], v[128:129], v[188:189] op_sel_hi:[1,0]
    v_pk_mul_f32 v[130:131], v[130:131], v[188:189] op_sel_hi:[1,0]
    v_cvt_pk_bf16_f32 v174, v196, v197
    v_mfma_f32_16x16x32_bf16 v[152:155], v[36:39], v[140:143], v[152:155]
    v_cvt_pk_bf16_f32 v175, v198, v199
    v_cvt_pk_bf16_f32 v128, v128, v129
    v_mfma_f32_16x16x32_bf16 v[152:155], v[68:71], v[164:167], v[152:155]
    buffer_store_dwordx4 v[172:175], v21, s[56:59], s52 offen sc1
    v_mfma_f32_16x16x32_bf16 v[248:251], v[40:43], v[116:119], 0
    v_cvt_pk_bf16_f32 v129, v130, v131
    v_exp_f32_e64 v202, v202
    v_mfma_f32_16x16x32_bf16 v[248:251], v[72:75], v[140:143], v[248:251]
    v_exp_f32_e64 v203, v203
    v_mfma_f32_16x16x32_bf16 v[248:251], v[44:47], v[164:167], v[248:251]
    v_cvt_pk_bf16_f32 v122, v200, v201
    v_cvt_pk_bf16_f32 v123, v202, v203
    v_mfma_f32_16x16x32_bf16 v[252:255], v[76:79], v[116:119], 0
    v_exp_f32 v132, v132
    v_exp_f32 v133, v133
    v_exp_f32_e64 v134, v134
    v_pk_mul_f32 v[152:153], v[152:153], v[188:189] op_sel_hi:[1,0]
    v_pk_mul_f32 v[154:155], v[154:155], v[188:189] op_sel_hi:[1,0]
    v_pk_mul_f32 v[248:249], v[248:249], v[188:189] op_sel_hi:[1,0]
    v_pk_mul_f32 v[250:251], v[250:251], v[188:189] op_sel_hi:[1,0]
    v_cvt_pk_bf16_f32 v130, v152, v153
    v_mfma_f32_16x16x32_bf16 v[252:255], v[48:51], v[140:143], v[252:255]
    v_cvt_pk_bf16_f32 v131, v154, v155
    v_cvt_pk_bf16_f32 v248, v248, v249
    v_mfma_f32_16x16x32_bf16 v[252:255], v[80:83], v[164:167], v[252:255]
    buffer_store_dwordx4 v[128:131], v21, s[56:59], s55 offen sc1
    v_mfma_f32_16x16x32_bf16 v[192:195], v[16:19], v[120:123], 0
    v_cvt_pk_bf16_f32 v249, v250, v251
    v_exp_f32_e64 v135, v135
    v_mfma_f32_16x16x32_bf16 v[176:179], v[88:91], v[120:123], 0
    v_cvt_pk_bf16_f32 v144, v132, v133
    v_cvt_pk_bf16_f32 v145, v134, v135
    v_mfma_f32_16x16x32_bf16 v[200:203], v[100:103], v[120:123], 0
    v_exp_f32_e64 v156, v156
    v_mfma_f32_16x16x32_bf16 v[132:135], v[232:235], v[120:123], 0
    v_exp_f32_e64 v157, v157
    v_mfma_f32_16x16x32_bf16 v[112:115], v[40:43], v[120:123], 0
    v_exp_f32_e64 v158, v158
    v_mfma_f32_16x16x32_bf16 v[136:139], v[76:79], v[120:123], 0
    v_exp_f32_e64 v159, v159
    v_cvt_pk_bf16_f32 v146, v156, v157
    v_exp_f32_e64 v180, v180
    v_pk_mul_f32 v[252:253], v[252:253], v[188:189] op_sel_hi:[1,0]
    v_pk_mul_f32 v[254:255], v[254:255], v[188:189] op_sel_hi:[1,0]
    v_cvt_pk_bf16_f32 v250, v252, v253
    v_cvt_pk_bf16_f32 v251, v254, v255
    v_cvt_pk_bf16_f32 v147, v158, v159
    v_mfma_f32_16x16x32_bf16 v[156:159], v[244:247], v[120:123], 0
    buffer_store_dwordx4 v[248:251], v21, s[56:59], s62 offen sc1
    v_mfma_f32_16x16x32_bf16 v[192:195], v[16:19], v[144:147], v[192:195]
    v_exp_f32_e64 v181, v181
    v_mfma_f32_16x16x32_bf16 v[176:179], v[92:95], v[144:147], v[176:179]
    v_exp_f32_e64 v182, v182
    v_mfma_f32_16x16x32_bf16 v[200:203], v[104:107], v[144:147], v[200:203]
    v_exp_f32_e64 v183, v183
    v_mfma_f32_16x16x32_bf16 v[132:135], v[236:239], v[144:147], v[132:135]
    v_cvt_pk_bf16_f32 v168, v180, v181
    v_cvt_pk_bf16_f32 v169, v182, v183
    v_mfma_f32_16x16x32_bf16 v[156:159], v[24:27], v[144:147], v[156:159]
    v_exp_f32_e64 v204, v204
    v_mfma_f32_16x16x32_bf16 v[180:183], v[28:31], v[120:123], 0
    v_exp_f32_e64 v205, v205
    v_mfma_f32_16x16x32_bf16 v[180:183], v[60:63], v[144:147], v[180:183]
    v_exp_f32_e64 v206, v206
    v_mfma_f32_16x16x32_bf16 v[112:115], v[72:75], v[144:147], v[112:115]
    v_exp_f32_e64 v207, v207
    v_mfma_f32_16x16x32_bf16 v[136:139], v[48:51], v[144:147], v[136:139]
    v_cvt_pk_bf16_f32 v170, v204, v205
    v_cvt_pk_bf16_f32 v171, v206, v207
    v_mfma_f32_16x16x32_bf16 v[204:207], v[64:67], v[120:123], 0
    s_nop 0
    v_mfma_f32_16x16x32_bf16 v[192:195], v[16:19], v[168:171], v[192:195]
    v_mfma_f32_16x16x32_bf16 v[176:179], v[96:99], v[168:171], v[176:179]
    v_mfma_f32_16x16x32_bf16 v[200:203], v[108:111], v[168:171], v[200:203]
    v_mfma_f32_16x16x32_bf16 v[132:135], v[240:243], v[168:171], v[132:135]
    s_nop 4
    v_rcp_f32 v192, v192
    s_nop 0
    v_pk_mul_f32 v[176:177], v[176:177], v[192:193] op_sel_hi:[1,0]
    v_pk_mul_f32 v[178:179], v[178:179], v[192:193] op_sel_hi:[1,0]
    v_pk_mul_f32 v[200:201], v[200:201], v[192:193] op_sel_hi:[1,0]
    v_pk_mul_f32 v[202:203], v[202:203], v[192:193] op_sel_hi:[1,0]
    v_cvt_pk_bf16_f32 v176, v176, v177
    v_pk_mul_f32 v[132:133], v[132:133], v[192:193] op_sel_hi:[1,0]
    v_pk_mul_f32 v[134:135], v[134:135], v[192:193] op_sel_hi:[1,0]
    v_cvt_pk_bf16_f32 v177, v178, v179
    v_mfma_f32_16x16x32_bf16 v[156:159], v[56:59], v[168:171], v[156:159]
    v_cvt_pk_bf16_f32 v178, v200, v201
    v_cvt_pk_bf16_f32 v179, v202, v203
    v_mfma_f32_16x16x32_bf16 v[180:183], v[32:35], v[168:171], v[180:183]
    buffer_store_dwordx4 v[176:179], v21, s[56:59], s50 offen sc1
    s_nop 3
    v_pk_mul_f32 v[156:157], v[156:157], v[192:193] op_sel_hi:[1,0]
    v_pk_mul_f32 v[158:159], v[158:159], v[192:193] op_sel_hi:[1,0]
    v_cvt_pk_bf16_f32 v132, v132, v133
    v_pk_mul_f32 v[180:181], v[180:181], v[192:193] op_sel_hi:[1,0]
    v_pk_mul_f32 v[182:183], v[182:183], v[192:193] op_sel_hi:[1,0]
    v_cvt_pk_bf16_f32 v133, v134, v135
    v_mfma_f32_16x16x32_bf16 v[204:207], v[36:39], v[144:147], v[204:207]
    v_cvt_pk_bf16_f32 v134, v156, v157
    v_cvt_pk_bf16_f32 v135, v158, v159
    v_mfma_f32_16x16x32_bf16 v[204:207], v[68:71], v[168:171], v[204:207]
    buffer_store_dwordx4 v[132:135], v21, s[56:59], s53 offen sc1
    v_mfma_f32_16x16x32_bf16 v[112:115], v[44:47], v[168:171], v[112:115]
    v_cvt_pk_bf16_f32 v180, v180, v181
    v_cvt_pk_bf16_f32 v181, v182, v183
    v_mfma_f32_16x16x32_bf16 v[136:139], v[80:83], v[168:171], v[136:139]
    s_nop 2
    v_pk_mul_f32 v[204:205], v[204:205], v[192:193] op_sel_hi:[1,0]
    v_pk_mul_f32 v[206:207], v[206:207], v[192:193] op_sel_hi:[1,0]
    v_pk_mul_f32 v[112:113], v[112:113], v[192:193] op_sel_hi:[1,0]
    v_pk_mul_f32 v[114:115], v[114:115], v[192:193] op_sel_hi:[1,0]
    v_cvt_pk_bf16_f32 v182, v204, v205
    v_pk_mul_f32 v[136:137], v[136:137], v[192:193] op_sel_hi:[1,0]
    v_pk_mul_f32 v[138:139], v[138:139], v[192:193] op_sel_hi:[1,0]
    v_cvt_pk_bf16_f32 v183, v206, v207
    v_cvt_pk_bf16_f32 v112, v112, v113
    buffer_store_dwordx4 v[180:183], v21, s[56:59], s60 offen sc1
    v_cvt_pk_bf16_f32 v113, v114, v115
    v_cvt_pk_bf16_f32 v114, v136, v137
    v_cvt_pk_bf16_f32 v115, v138, v139
    buffer_store_dwordx4 v[112:115], v21, s[56:59], s63 offen sc1
    s_barrier
    v_bfe_u32 v5, v0, 2, 2
    v_and_b32 v6, 1, v3
    v_lshl_or_b32 v6, v6, 2, v5
    v_xor_b32_e64 v6, s22, v6
    v_lshl_add_u32 v5, v3, 2, v5
    v_lshlrev_b32 v5, 8, v5
    v_and_b32 v7, 3, v0
    v_lshl_add_u32 v5, v7, 3, v5
    v_xor_b32_e64 v7, 0, v6
    v_lshl_add_u32 v8, v7, 5, v5
    v_xor_b32_e64 v7, 1, v6
    v_lshl_add_u32 v9, v7, 5, v5
    v_xor_b32_e64 v7, 2, v6
    v_lshl_add_u32 v10, v7, 5, v5
    v_xor_b32_e64 v7, 3, v6
    v_lshl_add_u32 v11, v7, 5, v5
    v_add_u32 v12, 0x10000, v8
    v_add_u32 v13, 0x10000, v9
    v_add_u32 v14, 0x10000, v10
    v_add_u32 v15, 0x10000, v11
    v_add_u32 v16, s24, v22
    v_add_u32 v17, s25, v22
    v_add_u32 v18, s26, v22
    v_add_u32 v19, s27, v22
    v_readfirstlane_b32 s86, v2
    s_and_b32 s87, s3, 4
    s_nop 0
    s_lshr_b32 s87, s86, s87
    s_and_b32 s86, s86, 0x2000
    s_add_u32 s11, s11, s86
    s_xor_b32 s86, s86, s23
    s_add_u32 s17, s17, s86
    s_add_u32 s12, s38, 1
    s_and_b32 s12, s12, 3
    s_lshr_b32 s12, s87, s12
    s_and_b32 s12, s12, 1
    s_lshl_b32 s12, s12, 13
    s_xor_b32 s12, s12, s23
    s_add_u32 s14, s14, s12
    s_add_u32 s18, s18, s86
    s_add_u32 s12, s38, 2
    s_and_b32 s12, s12, 3
    s_lshr_b32 s12, s87, s12
    s_and_b32 s12, s12, 1
    s_lshl_b32 s12, s12, 13
    s_xor_b32 s12, s12, s23
    s_add_u32 s15, s15, s12
    s_add_u32 s19, s19, s86
    s_add_u32 s12, s38, 3
    s_and_b32 s12, s12, 3
    s_lshr_b32 s12, s87, s12
    s_and_b32 s12, s12, 1
    s_lshl_b32 s12, s12, 13
    s_xor_b32 s12, s12, s23
    s_add_u32 s16, s16, s12
    v_lshrrev_b32 v23, v0, s87
    v_and_b32 v23, 1, v23
    v_lshlrev_b32 v23, 13, v23
    v_mul_u32_u24 v7, 128, v0
    v_add_u32 v23, v7, v23
    v_mov_b32 v6, 1
    s_waitcnt vmcnt(0) lgkmcnt(0)
    s_cmp_ge_u32 s4, 30
    s_barrier
    s_cbranch_scc1 L_cdone
    s_barrier
    s_barrier
    ds_read_b64_tr_b16 v[24:25], v8 offset:32768
    ds_read_b64_tr_b16 v[26:27], v8 offset:36864
    ds_read_b128 v[56:59], v16 offset:0
    ds_read_b64_tr_b16 v[40:41], v8 offset:40960
    ds_read_b64_tr_b16 v[42:43], v8 offset:45056
    ds_read_b128 v[72:75], v16 offset:8192
    ds_read_b128 v[76:79], v17 offset:8192
    ds_read_b128 v[60:63], v17 offset:0
    ds_read_b128 v[64:67], v18 offset:0
    ds_read_b128 v[80:83], v18 offset:8192
    ds_read_b128 v[84:87], v19 offset:8192
    ds_read_b128 v[68:71], v19 offset:0
    s_waitcnt lgkmcnt(9)
    v_mfma_f32_16x16x32_bf16 v[152:155], v[24:27], v[56:59], 0
    ds_read_b64_tr_b16 v[28:29], v9 offset:32768
    ds_read_b64_tr_b16 v[30:31], v9 offset:36864
    s_waitcnt lgkmcnt(8)
    v_mfma_f32_16x16x32_bf16 v[152:155], v[40:43], v[72:75], v[152:155]
    ds_read_b64_tr_b16 v[44:45], v9 offset:40960
    ds_read_b64_tr_b16 v[46:47], v9 offset:45056
    s_waitcnt lgkmcnt(9)
    v_mfma_f32_16x16x32_bf16 v[156:159], v[40:43], v[76:79], 0
    ds_read_b64_tr_b16 v[32:33], v10 offset:32768
    ds_read_b64_tr_b16 v[34:35], v10 offset:36864
    s_waitcnt lgkmcnt(7)
    v_mfma_f32_16x16x32_bf16 v[156:159], v[24:27], v[60:63], v[156:159]
    ds_read_b64_tr_b16 v[48:49], v10 offset:40960
    ds_read_b64_tr_b16 v[50:51], v10 offset:45056
    v_mfma_f32_16x16x32_bf16 v[160:163], v[24:27], v[64:67], 0
    ds_read_b64_tr_b16 v[36:37], v11 offset:32768
    ds_read_b64_tr_b16 v[38:39], v11 offset:36864
    v_mfma_f32_16x16x32_bf16 v[160:163], v[40:43], v[80:83], v[160:163]
    ds_read_b64_tr_b16 v[52:53], v11 offset:40960
    ds_read_b64_tr_b16 v[54:55], v11 offset:45056
    v_mfma_f32_16x16x32_bf16 v[164:167], v[40:43], v[84:87], 0
    s_waitcnt lgkmcnt(8)
    v_mfma_f32_16x16x32_bf16 v[164:167], v[24:27], v[68:71], v[164:167]
    v_mfma_f32_16x16x32_bf16 v[180:183], v[28:31], v[68:71], 0
    v_mfma_f32_16x16x32_bf16 v[180:183], v[44:47], v[84:87], v[180:183]
    v_mfma_f32_16x16x32_bf16 v[176:179], v[44:47], v[80:83], 0
    v_mfma_f32_16x16x32_bf16 v[176:179], v[28:31], v[64:67], v[176:179]
    s_waitcnt lgkmcnt(0)
    s_barrier
    v_mfma_f32_16x16x32_bf16 v[172:175], v[28:31], v[60:63], 0
    ds_read_b64_tr_b16 v[88:89], v12 offset:32768
    ds_read_b64_tr_b16 v[90:91], v12 offset:36864
    v_mfma_f32_16x16x32_bf16 v[172:175], v[44:47], v[76:79], v[172:175]
    ds_read_b128 v[120:123], v16 offset:16384
    v_mfma_f32_16x16x32_bf16 v[168:171], v[44:47], v[72:75], 0
    ds_read_b64_tr_b16 v[104:105], v12 offset:40960
    v_mfma_f32_16x16x32_bf16 v[168:171], v[28:31], v[56:59], v[168:171]
    ds_read_b64_tr_b16 v[106:107], v12 offset:45056
    v_mfma_f32_16x16x32_bf16 v[184:187], v[32:35], v[56:59], 0
    ds_read_b128 v[136:139], v16 offset:24576
    v_mfma_f32_16x16x32_bf16 v[184:187], v[48:51], v[72:75], v[184:187]
    ds_read_b128 v[140:143], v17 offset:24576
    ds_read_b128 v[124:127], v17 offset:16384
    v_mfma_f32_16x16x32_bf16 v[188:191], v[48:51], v[76:79], 0
    ds_read_b128 v[128:131], v18 offset:16384
    v_mfma_f32_16x16x32_bf16 v[188:191], v[32:35], v[60:63], v[188:191]
    ds_read_b128 v[144:147], v18 offset:24576
    v_mfma_f32_16x16x32_bf16 v[192:195], v[32:35], v[64:67], 0
    ds_read_b128 v[148:151], v19 offset:24576
    v_mfma_f32_16x16x32_bf16 v[192:195], v[48:51], v[80:83], v[192:195]
    ds_read_b128 v[132:135], v19 offset:16384
    v_mfma_f32_16x16x32_bf16 v[196:199], v[48:51], v[84:87], 0
    ds_read_b64_tr_b16 v[92:93], v13 offset:32768
    ds_read_b64_tr_b16 v[94:95], v13 offset:36864
    v_mfma_f32_16x16x32_bf16 v[196:199], v[32:35], v[68:71], v[196:199]
    ds_read_b64_tr_b16 v[108:109], v13 offset:40960
    v_mfma_f32_16x16x32_bf16 v[212:215], v[36:39], v[68:71], 0
    ds_read_b64_tr_b16 v[110:111], v13 offset:45056
    v_mfma_f32_16x16x32_bf16 v[212:215], v[52:55], v[84:87], v[212:215]
    ds_read_b64_tr_b16 v[96:97], v14 offset:32768
    v_mfma_f32_16x16x32_bf16 v[208:211], v[52:55], v[80:83], 0
    ds_read_b64_tr_b16 v[98:99], v14 offset:36864
    v_mfma_f32_16x16x32_bf16 v[208:211], v[36:39], v[64:67], v[208:211]
    ds_read_b64_tr_b16 v[112:113], v14 offset:40960
    ds_read_b64_tr_b16 v[114:115], v14 offset:45056
    v_mfma_f32_16x16x32_bf16 v[204:207], v[36:39], v[60:63], 0
    ds_read_b64_tr_b16 v[100:101], v15 offset:32768
    v_mfma_f32_16x16x32_bf16 v[204:207], v[52:55], v[76:79], v[204:207]
    ds_read_b64_tr_b16 v[102:103], v15 offset:36864
    v_mfma_f32_16x16x32_bf16 v[200:203], v[52:55], v[72:75], 0
    ds_read_b64_tr_b16 v[116:117], v15 offset:40960
    v_mfma_f32_16x16x32_bf16 v[200:203], v[36:39], v[56:59], v[200:203]
    ds_read_b64_tr_b16 v[118:119], v15 offset:45056
    s_waitcnt lgkmcnt(7)
    v_mfma_f32_16x16x32_bf16 v[152:155], v[88:91], v[120:123], v[152:155]
    v_mfma_f32_16x16x32_bf16 v[152:155], v[104:107], v[136:139], v[152:155]
    v_mfma_f32_16x16x32_bf16 v[156:159], v[104:107], v[140:143], v[156:159]
    v_mfma_f32_16x16x32_bf16 v[156:159], v[88:91], v[124:127], v[156:159]
    v_mfma_f32_16x16x32_bf16 v[160:163], v[88:91], v[128:131], v[160:163]
    v_mfma_f32_16x16x32_bf16 v[160:163], v[104:107], v[144:147], v[160:163]
    v_mfma_f32_16x16x32_bf16 v[164:167], v[104:107], v[148:151], v[164:167]
    v_mfma_f32_16x16x32_bf16 v[164:167], v[88:91], v[132:135], v[164:167]
    s_waitcnt lgkmcnt(0)
    s_barrier
    v_mfma_f32_16x16x32_bf16 v[180:183], v[92:95], v[132:135], v[180:183]
    ds_read_b64_tr_b16 v[24:25], v8 offset:0
    v_mfma_f32_16x16x32_bf16 v[180:183], v[108:111], v[148:151], v[180:183]
    ds_read_b64_tr_b16 v[26:27], v8 offset:4096
    v_mfma_f32_16x16x32_bf16 v[176:179], v[108:111], v[144:147], v[176:179]
    ds_read_b128 v[56:59], v16 offset:32768
    v_mfma_f32_16x16x32_bf16 v[176:179], v[92:95], v[128:131], v[176:179]
    ds_read_b64_tr_b16 v[40:41], v8 offset:8192
    v_mfma_f32_16x16x32_bf16 v[172:175], v[92:95], v[124:127], v[172:175]
    ds_read_b64_tr_b16 v[42:43], v8 offset:12288
    v_mfma_f32_16x16x32_bf16 v[172:175], v[108:111], v[140:143], v[172:175]
    ds_read_b128 v[72:75], v16 offset:40960
    v_mfma_f32_16x16x32_bf16 v[168:171], v[108:111], v[136:139], v[168:171]
    ds_read_b128 v[76:79], v17 offset:40960
    v_mfma_f32_16x16x32_bf16 v[168:171], v[92:95], v[120:123], v[168:171]
    ds_read_b128 v[60:63], v17 offset:32768
    v_mfma_f32_16x16x32_bf16 v[184:187], v[96:99], v[120:123], v[184:187]
    ds_read_b128 v[64:67], v18 offset:32768
    v_mfma_f32_16x16x32_bf16 v[184:187], v[112:115], v[136:139], v[184:187]
    ds_read_b128 v[80:83], v18 offset:40960
    v_mfma_f32_16x16x32_bf16 v[188:191], v[112:115], v[140:143], v[188:191]
    ds_read_b128 v[84:87], v19 offset:40960
    v_mfma_f32_16x16x32_bf16 v[188:191], v[96:99], v[124:127], v[188:191]
    ds_read_b128 v[68:71], v19 offset:32768
    v_mfma_f32_16x16x32_bf16 v[192:195], v[96:99], v[128:131], v[192:195]
    ds_read_b64_tr_b16 v[28:29], v9 offset:0
    v_mfma_f32_16x16x32_bf16 v[192:195], v[112:115], v[144:147], v[192:195]
    ds_read_b64_tr_b16 v[30:31], v9 offset:4096
    v_mfma_f32_16x16x32_bf16 v[196:199], v[112:115], v[148:151], v[196:199]
    ds_read_b64_tr_b16 v[44:45], v9 offset:8192
    v_mfma_f32_16x16x32_bf16 v[196:199], v[96:99], v[132:135], v[196:199]
    ds_read_b64_tr_b16 v[46:47], v9 offset:12288
    v_mfma_f32_16x16x32_bf16 v[212:215], v[100:103], v[132:135], v[212:215]
    ds_read_b64_tr_b16 v[32:33], v10 offset:0
    v_mfma_f32_16x16x32_bf16 v[212:215], v[116:119], v[148:151], v[212:215]
    ds_read_b64_tr_b16 v[34:35], v10 offset:4096
    v_mfma_f32_16x16x32_bf16 v[208:211], v[116:119], v[144:147], v[208:211]
    ds_read_b64_tr_b16 v[48:49], v10 offset:8192
    v_mfma_f32_16x16x32_bf16 v[208:211], v[100:103], v[128:131], v[208:211]
    ds_read_b64_tr_b16 v[50:51], v10 offset:12288
    v_mfma_f32_16x16x32_bf16 v[204:207], v[100:103], v[124:127], v[204:207]
    ds_read_b64_tr_b16 v[36:37], v11 offset:0
    v_mfma_f32_16x16x32_bf16 v[204:207], v[116:119], v[140:143], v[204:207]
    ds_read_b64_tr_b16 v[38:39], v11 offset:4096
    v_mfma_f32_16x16x32_bf16 v[200:203], v[116:119], v[136:139], v[200:203]
    ds_read_b64_tr_b16 v[52:53], v11 offset:8192
    v_mfma_f32_16x16x32_bf16 v[200:203], v[100:103], v[120:123], v[200:203]
    ds_read_b64_tr_b16 v[54:55], v11 offset:12288
    s_waitcnt lgkmcnt(7)
    v_mfma_f32_16x16x32_bf16 v[152:155], v[24:27], v[56:59], v[152:155]
    v_mfma_f32_16x16x32_bf16 v[152:155], v[40:43], v[72:75], v[152:155]
    v_mfma_f32_16x16x32_bf16 v[156:159], v[40:43], v[76:79], v[156:159]
    v_mfma_f32_16x16x32_bf16 v[156:159], v[24:27], v[60:63], v[156:159]
    v_mfma_f32_16x16x32_bf16 v[160:163], v[24:27], v[64:67], v[160:163]
    v_mfma_f32_16x16x32_bf16 v[160:163], v[40:43], v[80:83], v[160:163]
    v_mfma_f32_16x16x32_bf16 v[164:167], v[40:43], v[84:87], v[164:167]
    v_mfma_f32_16x16x32_bf16 v[164:167], v[24:27], v[68:71], v[164:167]
    s_waitcnt lgkmcnt(0)
    s_barrier
    v_mfma_f32_16x16x32_bf16 v[180:183], v[28:31], v[68:71], v[180:183]
    ds_read_b64_tr_b16 v[88:89], v8 offset:16384
    v_mfma_f32_16x16x32_bf16 v[180:183], v[44:47], v[84:87], v[180:183]
    ds_read_b64_tr_b16 v[90:91], v8 offset:20480
    v_mfma_f32_16x16x32_bf16 v[176:179], v[44:47], v[80:83], v[176:179]
    ds_read_b128 v[120:123], v16 offset:0
    v_mfma_f32_16x16x32_bf16 v[176:179], v[28:31], v[64:67], v[176:179]
    ds_read_b64_tr_b16 v[104:105], v8 offset:24576
    v_mfma_f32_16x16x32_bf16 v[172:175], v[28:31], v[60:63], v[172:175]
    ds_read_b64_tr_b16 v[106:107], v8 offset:28672
    v_mfma_f32_16x16x32_bf16 v[172:175], v[44:47], v[76:79], v[172:175]
    ds_read_b128 v[136:139], v16 offset:8192
    v_mfma_f32_16x16x32_bf16 v[168:171], v[44:47], v[72:75], v[168:171]
    ds_read_b128 v[140:143], v17 offset:8192
    v_mfma_f32_16x16x32_bf16 v[168:171], v[28:31], v[56:59], v[168:171]
    ds_read_b128 v[124:127], v17 offset:0
    v_mfma_f32_16x16x32_bf16 v[184:187], v[32:35], v[56:59], v[184:187]
    ds_read_b128 v[128:131], v18 offset:0
    v_mfma_f32_16x16x32_bf16 v[184:187], v[48:51], v[72:75], v[184:187]
    ds_read_b128 v[144:147], v18 offset:8192
    v_mfma_f32_16x16x32_bf16 v[188:191], v[48:51], v[76:79], v[188:191]
    ds_read_b128 v[148:151], v19 offset:8192
    v_mfma_f32_16x16x32_bf16 v[188:191], v[32:35], v[60:63], v[188:191]
    ds_read_b128 v[132:135], v19 offset:0
    v_mfma_f32_16x16x32_bf16 v[192:195], v[32:35], v[64:67], v[192:195]
    ds_read_b64_tr_b16 v[92:93], v9 offset:16384
    v_mfma_f32_16x16x32_bf16 v[192:195], v[48:51], v[80:83], v[192:195]
    ds_read_b64_tr_b16 v[94:95], v9 offset:20480
    v_mfma_f32_16x16x32_bf16 v[196:199], v[48:51], v[84:87], v[196:199]
    ds_read_b64_tr_b16 v[108:109], v9 offset:24576
    v_mfma_f32_16x16x32_bf16 v[196:199], v[32:35], v[68:71], v[196:199]
    ds_read_b64_tr_b16 v[110:111], v9 offset:28672
    v_mfma_f32_16x16x32_bf16 v[212:215], v[36:39], v[68:71], v[212:215]
    ds_read_b64_tr_b16 v[96:97], v10 offset:16384
    v_mfma_f32_16x16x32_bf16 v[212:215], v[52:55], v[84:87], v[212:215]
    ds_read_b64_tr_b16 v[98:99], v10 offset:20480
    v_mfma_f32_16x16x32_bf16 v[208:211], v[52:55], v[80:83], v[208:211]
    ds_read_b64_tr_b16 v[112:113], v10 offset:24576
    v_mfma_f32_16x16x32_bf16 v[208:211], v[36:39], v[64:67], v[208:211]
    ds_read_b64_tr_b16 v[114:115], v10 offset:28672
    v_mfma_f32_16x16x32_bf16 v[204:207], v[36:39], v[60:63], v[204:207]
    ds_read_b64_tr_b16 v[100:101], v11 offset:16384
    v_mfma_f32_16x16x32_bf16 v[204:207], v[52:55], v[76:79], v[204:207]
    ds_read_b64_tr_b16 v[102:103], v11 offset:20480
    v_mfma_f32_16x16x32_bf16 v[200:203], v[52:55], v[72:75], v[200:203]
    ds_read_b64_tr_b16 v[116:117], v11 offset:24576
    v_mfma_f32_16x16x32_bf16 v[200:203], v[36:39], v[56:59], v[200:203]
    ds_read_b64_tr_b16 v[118:119], v11 offset:28672
    s_waitcnt lgkmcnt(7)
    v_mfma_f32_16x16x32_bf16 v[152:155], v[88:91], v[120:123], v[152:155]
    v_mfma_f32_16x16x32_bf16 v[152:155], v[104:107], v[136:139], v[152:155]
    v_mfma_f32_16x16x32_bf16 v[156:159], v[104:107], v[140:143], v[156:159]
    v_mfma_f32_16x16x32_bf16 v[156:159], v[88:91], v[124:127], v[156:159]
    v_mfma_f32_16x16x32_bf16 v[160:163], v[88:91], v[128:131], v[160:163]
    v_mfma_f32_16x16x32_bf16 v[160:163], v[104:107], v[144:147], v[160:163]
    v_mfma_f32_16x16x32_bf16 v[164:167], v[104:107], v[148:151], v[164:167]
    v_mfma_f32_16x16x32_bf16 v[164:167], v[88:91], v[132:135], v[164:167]
    s_waitcnt lgkmcnt(0)
    s_barrier
    v_mfma_f32_16x16x32_bf16 v[180:183], v[92:95], v[132:135], v[180:183]
    ds_read_b64_tr_b16 v[24:25], v8 offset:49152
    v_mfma_f32_16x16x32_bf16 v[180:183], v[108:111], v[148:151], v[180:183]
    ds_read_b64_tr_b16 v[26:27], v8 offset:53248
    v_mfma_f32_16x16x32_bf16 v[176:179], v[108:111], v[144:147], v[176:179]
    ds_read_b128 v[56:59], v16 offset:16384
    v_mfma_f32_16x16x32_bf16 v[176:179], v[92:95], v[128:131], v[176:179]
    ds_read_b64_tr_b16 v[40:41], v8 offset:57344
    v_mfma_f32_16x16x32_bf16 v[172:175], v[92:95], v[124:127], v[172:175]
    ds_read_b64_tr_b16 v[42:43], v8 offset:61440
    v_mfma_f32_16x16x32_bf16 v[172:175], v[108:111], v[140:143], v[172:175]
    ds_read_b128 v[72:75], v16 offset:24576
    v_mfma_f32_16x16x32_bf16 v[168:171], v[108:111], v[136:139], v[168:171]
    ds_read_b128 v[76:79], v17 offset:24576
    v_mfma_f32_16x16x32_bf16 v[168:171], v[92:95], v[120:123], v[168:171]
    ds_read_b128 v[60:63], v17 offset:16384
    v_mfma_f32_16x16x32_bf16 v[184:187], v[96:99], v[120:123], v[184:187]
    ds_read_b128 v[64:67], v18 offset:16384
    v_mfma_f32_16x16x32_bf16 v[184:187], v[112:115], v[136:139], v[184:187]
    ds_read_b128 v[80:83], v18 offset:24576
    v_mfma_f32_16x16x32_bf16 v[188:191], v[112:115], v[140:143], v[188:191]
    ds_read_b128 v[84:87], v19 offset:24576
    v_mfma_f32_16x16x32_bf16 v[188:191], v[96:99], v[124:127], v[188:191]
    ds_read_b128 v[68:71], v19 offset:16384
    v_mfma_f32_16x16x32_bf16 v[192:195], v[96:99], v[128:131], v[192:195]
    ds_read_b64_tr_b16 v[28:29], v9 offset:49152
    v_mfma_f32_16x16x32_bf16 v[192:195], v[112:115], v[144:147], v[192:195]
    ds_read_b64_tr_b16 v[30:31], v9 offset:53248
    v_mfma_f32_16x16x32_bf16 v[196:199], v[112:115], v[148:151], v[196:199]
    ds_read_b64_tr_b16 v[44:45], v9 offset:57344
    v_mfma_f32_16x16x32_bf16 v[196:199], v[96:99], v[132:135], v[196:199]
    ds_read_b64_tr_b16 v[46:47], v9 offset:61440
    v_mfma_f32_16x16x32_bf16 v[212:215], v[100:103], v[132:135], v[212:215]
    ds_read_b64_tr_b16 v[32:33], v10 offset:49152
    v_mfma_f32_16x16x32_bf16 v[212:215], v[116:119], v[148:151], v[212:215]
    ds_read_b64_tr_b16 v[34:35], v10 offset:53248
    v_mfma_f32_16x16x32_bf16 v[208:211], v[116:119], v[144:147], v[208:211]
    ds_read_b64_tr_b16 v[48:49], v10 offset:57344
    v_mfma_f32_16x16x32_bf16 v[208:211], v[100:103], v[128:131], v[208:211]
    ds_read_b64_tr_b16 v[50:51], v10 offset:61440
    v_mfma_f32_16x16x32_bf16 v[204:207], v[100:103], v[124:127], v[204:207]
    ds_read_b64_tr_b16 v[36:37], v11 offset:49152
    v_mfma_f32_16x16x32_bf16 v[204:207], v[116:119], v[140:143], v[204:207]
    ds_read_b64_tr_b16 v[38:39], v11 offset:53248
    v_mfma_f32_16x16x32_bf16 v[200:203], v[116:119], v[136:139], v[200:203]
    ds_read_b64_tr_b16 v[52:53], v11 offset:57344
    v_mfma_f32_16x16x32_bf16 v[200:203], v[100:103], v[120:123], v[200:203]
    ds_read_b64_tr_b16 v[54:55], v11 offset:61440
    s_waitcnt lgkmcnt(7)
    v_mfma_f32_16x16x32_bf16 v[152:155], v[24:27], v[56:59], v[152:155]
    v_mfma_f32_16x16x32_bf16 v[152:155], v[40:43], v[72:75], v[152:155]
    v_mfma_f32_16x16x32_bf16 v[156:159], v[40:43], v[76:79], v[156:159]
    v_mfma_f32_16x16x32_bf16 v[156:159], v[24:27], v[60:63], v[156:159]
    v_mfma_f32_16x16x32_bf16 v[160:163], v[24:27], v[64:67], v[160:163]
    v_mfma_f32_16x16x32_bf16 v[160:163], v[40:43], v[80:83], v[160:163]
    v_mfma_f32_16x16x32_bf16 v[164:167], v[40:43], v[84:87], v[164:167]
    v_mfma_f32_16x16x32_bf16 v[164:167], v[24:27], v[68:71], v[164:167]
    s_waitcnt lgkmcnt(0)
    s_barrier
    v_mfma_f32_16x16x32_bf16 v[180:183], v[28:31], v[68:71], v[180:183]
    ds_read_b64_tr_b16 v[88:89], v12 offset:0
    v_mfma_f32_16x16x32_bf16 v[180:183], v[44:47], v[84:87], v[180:183]
    ds_read_b64_tr_b16 v[90:91], v12 offset:4096
    v_mfma_f32_16x16x32_bf16 v[176:179], v[44:47], v[80:83], v[176:179]
    ds_read_b128 v[120:123], v16 offset:32768
    v_mfma_f32_16x16x32_bf16 v[176:179], v[28:31], v[64:67], v[176:179]
    ds_read_b64_tr_b16 v[104:105], v12 offset:8192
    v_mfma_f32_16x16x32_bf16 v[172:175], v[28:31], v[60:63], v[172:175]
    ds_read_b64_tr_b16 v[106:107], v12 offset:12288
    v_mfma_f32_16x16x32_bf16 v[172:175], v[44:47], v[76:79], v[172:175]
    ds_read_b128 v[136:139], v16 offset:40960
    v_mfma_f32_16x16x32_bf16 v[168:171], v[44:47], v[72:75], v[168:171]
    ds_read_b128 v[140:143], v17 offset:40960
    v_mfma_f32_16x16x32_bf16 v[168:171], v[28:31], v[56:59], v[168:171]
    ds_read_b128 v[124:127], v17 offset:32768
    v_mfma_f32_16x16x32_bf16 v[184:187], v[32:35], v[56:59], v[184:187]
    ds_read_b128 v[128:131], v18 offset:32768
    v_mfma_f32_16x16x32_bf16 v[184:187], v[48:51], v[72:75], v[184:187]
    ds_read_b128 v[144:147], v18 offset:40960
    v_mfma_f32_16x16x32_bf16 v[188:191], v[48:51], v[76:79], v[188:191]
    ds_read_b128 v[148:151], v19 offset:40960
    v_mfma_f32_16x16x32_bf16 v[188:191], v[32:35], v[60:63], v[188:191]
    ds_read_b128 v[132:135], v19 offset:32768
    v_mfma_f32_16x16x32_bf16 v[192:195], v[32:35], v[64:67], v[192:195]
    ds_read_b64_tr_b16 v[92:93], v13 offset:0
    v_mfma_f32_16x16x32_bf16 v[192:195], v[48:51], v[80:83], v[192:195]
    ds_read_b64_tr_b16 v[94:95], v13 offset:4096
    v_mfma_f32_16x16x32_bf16 v[196:199], v[48:51], v[84:87], v[196:199]
    ds_read_b64_tr_b16 v[108:109], v13 offset:8192
    v_mfma_f32_16x16x32_bf16 v[196:199], v[32:35], v[68:71], v[196:199]
    ds_read_b64_tr_b16 v[110:111], v13 offset:12288
    v_mfma_f32_16x16x32_bf16 v[212:215], v[36:39], v[68:71], v[212:215]
    ds_read_b64_tr_b16 v[96:97], v14 offset:0
    v_mfma_f32_16x16x32_bf16 v[212:215], v[52:55], v[84:87], v[212:215]
    ds_read_b64_tr_b16 v[98:99], v14 offset:4096
    v_mfma_f32_16x16x32_bf16 v[208:211], v[52:55], v[80:83], v[208:211]
    ds_read_b64_tr_b16 v[112:113], v14 offset:8192
    v_mfma_f32_16x16x32_bf16 v[208:211], v[36:39], v[64:67], v[208:211]
    ds_read_b64_tr_b16 v[114:115], v14 offset:12288
    v_mfma_f32_16x16x32_bf16 v[204:207], v[36:39], v[60:63], v[204:207]
    ds_read_b64_tr_b16 v[100:101], v15 offset:0
    v_mfma_f32_16x16x32_bf16 v[204:207], v[52:55], v[76:79], v[204:207]
    ds_read_b64_tr_b16 v[102:103], v15 offset:4096
    v_mfma_f32_16x16x32_bf16 v[200:203], v[52:55], v[72:75], v[200:203]
    ds_read_b64_tr_b16 v[116:117], v15 offset:8192
    v_mfma_f32_16x16x32_bf16 v[200:203], v[36:39], v[56:59], v[200:203]
    ds_read_b64_tr_b16 v[118:119], v15 offset:12288
    s_waitcnt lgkmcnt(7)
    v_mfma_f32_16x16x32_bf16 v[152:155], v[88:91], v[120:123], v[152:155]
    v_mfma_f32_16x16x32_bf16 v[152:155], v[104:107], v[136:139], v[152:155]
    v_mfma_f32_16x16x32_bf16 v[156:159], v[104:107], v[140:143], v[156:159]
    v_mfma_f32_16x16x32_bf16 v[156:159], v[88:91], v[124:127], v[156:159]
    v_mfma_f32_16x16x32_bf16 v[160:163], v[88:91], v[128:131], v[160:163]
    v_mfma_f32_16x16x32_bf16 v[160:163], v[104:107], v[144:147], v[160:163]
    v_mfma_f32_16x16x32_bf16 v[164:167], v[104:107], v[148:151], v[164:167]
    v_mfma_f32_16x16x32_bf16 v[164:167], v[88:91], v[132:135], v[164:167]
    s_waitcnt lgkmcnt(0)
    s_barrier
    v_mfma_f32_16x16x32_bf16 v[180:183], v[92:95], v[132:135], v[180:183]
    ds_read_b64_tr_b16 v[24:25], v12 offset:16384
    v_mfma_f32_16x16x32_bf16 v[180:183], v[108:111], v[148:151], v[180:183]
    ds_read_b64_tr_b16 v[26:27], v12 offset:20480
    v_mfma_f32_16x16x32_bf16 v[176:179], v[108:111], v[144:147], v[176:179]
    ds_read_b128 v[56:59], v16 offset:0
    v_mfma_f32_16x16x32_bf16 v[176:179], v[92:95], v[128:131], v[176:179]
    ds_read_b64_tr_b16 v[40:41], v12 offset:24576
    v_mfma_f32_16x16x32_bf16 v[172:175], v[92:95], v[124:127], v[172:175]
    ds_read_b64_tr_b16 v[42:43], v12 offset:28672
    v_mfma_f32_16x16x32_bf16 v[172:175], v[108:111], v[140:143], v[172:175]
    ds_read_b128 v[72:75], v16 offset:8192
    v_mfma_f32_16x16x32_bf16 v[168:171], v[108:111], v[136:139], v[168:171]
    ds_read_b128 v[76:79], v17 offset:8192
    v_mfma_f32_16x16x32_bf16 v[168:171], v[92:95], v[120:123], v[168:171]
    ds_read_b128 v[60:63], v17 offset:0
    v_mfma_f32_16x16x32_bf16 v[184:187], v[96:99], v[120:123], v[184:187]
    ds_read_b128 v[64:67], v18 offset:0
    v_mfma_f32_16x16x32_bf16 v[184:187], v[112:115], v[136:139], v[184:187]
    ds_read_b128 v[80:83], v18 offset:8192
    v_mfma_f32_16x16x32_bf16 v[188:191], v[112:115], v[140:143], v[188:191]
    ds_read_b128 v[84:87], v19 offset:8192
    v_mfma_f32_16x16x32_bf16 v[188:191], v[96:99], v[124:127], v[188:191]
    ds_read_b128 v[68:71], v19 offset:0
    v_mfma_f32_16x16x32_bf16 v[192:195], v[96:99], v[128:131], v[192:195]
    ds_read_b64_tr_b16 v[28:29], v13 offset:16384
    v_mfma_f32_16x16x32_bf16 v[192:195], v[112:115], v[144:147], v[192:195]
    ds_read_b64_tr_b16 v[30:31], v13 offset:20480
    v_mfma_f32_16x16x32_bf16 v[196:199], v[112:115], v[148:151], v[196:199]
    ds_read_b64_tr_b16 v[44:45], v13 offset:24576
    v_mfma_f32_16x16x32_bf16 v[196:199], v[96:99], v[132:135], v[196:199]
    ds_read_b64_tr_b16 v[46:47], v13 offset:28672
    v_mfma_f32_16x16x32_bf16 v[212:215], v[100:103], v[132:135], v[212:215]
    ds_read_b64_tr_b16 v[32:33], v14 offset:16384
    v_mfma_f32_16x16x32_bf16 v[212:215], v[116:119], v[148:151], v[212:215]
    ds_read_b64_tr_b16 v[34:35], v14 offset:20480
    v_mfma_f32_16x16x32_bf16 v[208:211], v[116:119], v[144:147], v[208:211]
    ds_read_b64_tr_b16 v[48:49], v14 offset:24576
    v_mfma_f32_16x16x32_bf16 v[208:211], v[100:103], v[128:131], v[208:211]
    ds_read_b64_tr_b16 v[50:51], v14 offset:28672
    v_mfma_f32_16x16x32_bf16 v[204:207], v[100:103], v[124:127], v[204:207]
    ds_read_b64_tr_b16 v[36:37], v15 offset:16384
    v_mfma_f32_16x16x32_bf16 v[204:207], v[116:119], v[140:143], v[204:207]
    ds_read_b64_tr_b16 v[38:39], v15 offset:20480
    v_mfma_f32_16x16x32_bf16 v[200:203], v[116:119], v[136:139], v[200:203]
    ds_read_b64_tr_b16 v[52:53], v15 offset:24576
    v_mfma_f32_16x16x32_bf16 v[200:203], v[100:103], v[120:123], v[200:203]
    ds_read_b64_tr_b16 v[54:55], v15 offset:28672
    s_waitcnt lgkmcnt(7)
    v_mfma_f32_16x16x32_bf16 v[152:155], v[24:27], v[56:59], v[152:155]
    v_mfma_f32_16x16x32_bf16 v[152:155], v[40:43], v[72:75], v[152:155]
    v_mfma_f32_16x16x32_bf16 v[156:159], v[40:43], v[76:79], v[156:159]
    v_mfma_f32_16x16x32_bf16 v[156:159], v[24:27], v[60:63], v[156:159]
    v_mfma_f32_16x16x32_bf16 v[160:163], v[24:27], v[64:67], v[160:163]
    v_mfma_f32_16x16x32_bf16 v[160:163], v[40:43], v[80:83], v[160:163]
    v_mfma_f32_16x16x32_bf16 v[164:167], v[40:43], v[84:87], v[164:167]
    v_mfma_f32_16x16x32_bf16 v[164:167], v[24:27], v[68:71], v[164:167]
    s_waitcnt lgkmcnt(0)
    s_barrier
    v_mfma_f32_16x16x32_bf16 v[180:183], v[28:31], v[68:71], v[180:183]
    ds_read_b64_tr_b16 v[88:89], v8 offset:32768
    v_mfma_f32_16x16x32_bf16 v[180:183], v[44:47], v[84:87], v[180:183]
    ds_read_b64_tr_b16 v[90:91], v8 offset:36864
    v_mfma_f32_16x16x32_bf16 v[176:179], v[44:47], v[80:83], v[176:179]
    ds_read_b128 v[120:123], v16 offset:16384
    v_mfma_f32_16x16x32_bf16 v[176:179], v[28:31], v[64:67], v[176:179]
    ds_read_b64_tr_b16 v[104:105], v8 offset:40960
    v_mfma_f32_16x16x32_bf16 v[172:175], v[28:31], v[60:63], v[172:175]
    ds_read_b64_tr_b16 v[106:107], v8 offset:45056
    v_mfma_f32_16x16x32_bf16 v[172:175], v[44:47], v[76:79], v[172:175]
    ds_read_b128 v[136:139], v16 offset:24576
    v_mfma_f32_16x16x32_bf16 v[168:171], v[44:47], v[72:75], v[168:171]
    ds_read_b128 v[140:143], v17 offset:24576
    v_mfma_f32_16x16x32_bf16 v[168:171], v[28:31], v[56:59], v[168:171]
    ds_read_b128 v[124:127], v17 offset:16384
    v_mfma_f32_16x16x32_bf16 v[184:187], v[32:35], v[56:59], v[184:187]
    ds_read_b128 v[128:131], v18 offset:16384
    v_mfma_f32_16x16x32_bf16 v[184:187], v[48:51], v[72:75], v[184:187]
    ds_read_b128 v[144:147], v18 offset:24576
    v_mfma_f32_16x16x32_bf16 v[188:191], v[48:51], v[76:79], v[188:191]
    ds_read_b128 v[148:151], v19 offset:24576
    v_mfma_f32_16x16x32_bf16 v[188:191], v[32:35], v[60:63], v[188:191]
    ds_read_b128 v[132:135], v19 offset:16384
    v_mfma_f32_16x16x32_bf16 v[192:195], v[32:35], v[64:67], v[192:195]
    ds_read_b64_tr_b16 v[92:93], v9 offset:32768
    v_mfma_f32_16x16x32_bf16 v[192:195], v[48:51], v[80:83], v[192:195]
    ds_read_b64_tr_b16 v[94:95], v9 offset:36864
    v_mfma_f32_16x16x32_bf16 v[196:199], v[48:51], v[84:87], v[196:199]
    ds_read_b64_tr_b16 v[108:109], v9 offset:40960
    v_mfma_f32_16x16x32_bf16 v[196:199], v[32:35], v[68:71], v[196:199]
    ds_read_b64_tr_b16 v[110:111], v9 offset:45056
    v_mfma_f32_16x16x32_bf16 v[212:215], v[36:39], v[68:71], v[212:215]
    ds_read_b64_tr_b16 v[96:97], v10 offset:32768
    v_mfma_f32_16x16x32_bf16 v[212:215], v[52:55], v[84:87], v[212:215]
    ds_read_b64_tr_b16 v[98:99], v10 offset:36864
    v_mfma_f32_16x16x32_bf16 v[208:211], v[52:55], v[80:83], v[208:211]
    ds_read_b64_tr_b16 v[112:113], v10 offset:40960
    v_mfma_f32_16x16x32_bf16 v[208:211], v[36:39], v[64:67], v[208:211]
    ds_read_b64_tr_b16 v[114:115], v10 offset:45056
    v_mfma_f32_16x16x32_bf16 v[204:207], v[36:39], v[60:63], v[204:207]
    ds_read_b64_tr_b16 v[100:101], v11 offset:32768
    v_mfma_f32_16x16x32_bf16 v[204:207], v[52:55], v[76:79], v[204:207]
    ds_read_b64_tr_b16 v[102:103], v11 offset:36864
    v_mfma_f32_16x16x32_bf16 v[200:203], v[52:55], v[72:75], v[200:203]
    ds_read_b64_tr_b16 v[116:117], v11 offset:40960
    v_mfma_f32_16x16x32_bf16 v[200:203], v[36:39], v[56:59], v[200:203]
    ds_read_b64_tr_b16 v[118:119], v11 offset:45056
    s_waitcnt lgkmcnt(7)
    v_mfma_f32_16x16x32_bf16 v[152:155], v[88:91], v[120:123], v[152:155]
    v_mfma_f32_16x16x32_bf16 v[152:155], v[104:107], v[136:139], v[152:155]
    v_mfma_f32_16x16x32_bf16 v[156:159], v[104:107], v[140:143], v[156:159]
    v_mfma_f32_16x16x32_bf16 v[156:159], v[88:91], v[124:127], v[156:159]
    v_mfma_f32_16x16x32_bf16 v[160:163], v[88:91], v[128:131], v[160:163]
    v_mfma_f32_16x16x32_bf16 v[160:163], v[104:107], v[144:147], v[160:163]
    v_mfma_f32_16x16x32_bf16 v[164:167], v[104:107], v[148:151], v[164:167]
    v_mfma_f32_16x16x32_bf16 v[164:167], v[88:91], v[132:135], v[164:167]
    s_waitcnt lgkmcnt(0)
    s_barrier
    v_mfma_f32_16x16x32_bf16 v[180:183], v[92:95], v[132:135], v[180:183]
    ds_read_b64_tr_b16 v[24:25], v12 offset:32768
    v_mfma_f32_16x16x32_bf16 v[180:183], v[108:111], v[148:151], v[180:183]
    ds_read_b64_tr_b16 v[26:27], v12 offset:36864
    v_mfma_f32_16x16x32_bf16 v[176:179], v[108:111], v[144:147], v[176:179]
    ds_read_b128 v[56:59], v16 offset:32768
    v_mfma_f32_16x16x32_bf16 v[176:179], v[92:95], v[128:131], v[176:179]
    ds_read_b64_tr_b16 v[40:41], v12 offset:40960
    v_mfma_f32_16x16x32_bf16 v[172:175], v[92:95], v[124:127], v[172:175]
    ds_read_b64_tr_b16 v[42:43], v12 offset:45056
    v_mfma_f32_16x16x32_bf16 v[172:175], v[108:111], v[140:143], v[172:175]
    ds_read_b128 v[72:75], v16 offset:40960
    v_mfma_f32_16x16x32_bf16 v[168:171], v[108:111], v[136:139], v[168:171]
    ds_read_b128 v[76:79], v17 offset:40960
    v_mfma_f32_16x16x32_bf16 v[168:171], v[92:95], v[120:123], v[168:171]
    ds_read_b128 v[60:63], v17 offset:32768
    v_mfma_f32_16x16x32_bf16 v[184:187], v[96:99], v[120:123], v[184:187]
    ds_read_b128 v[64:67], v18 offset:32768
    v_mfma_f32_16x16x32_bf16 v[184:187], v[112:115], v[136:139], v[184:187]
    ds_read_b128 v[80:83], v18 offset:40960
    v_mfma_f32_16x16x32_bf16 v[188:191], v[112:115], v[140:143], v[188:191]
    ds_read_b128 v[84:87], v19 offset:40960
    v_mfma_f32_16x16x32_bf16 v[188:191], v[96:99], v[124:127], v[188:191]
    ds_read_b128 v[68:71], v19 offset:32768
    v_mfma_f32_16x16x32_bf16 v[192:195], v[96:99], v[128:131], v[192:195]
    ds_read_b64_tr_b16 v[28:29], v13 offset:32768
    v_mfma_f32_16x16x32_bf16 v[192:195], v[112:115], v[144:147], v[192:195]
    ds_read_b64_tr_b16 v[30:31], v13 offset:36864
    v_mfma_f32_16x16x32_bf16 v[196:199], v[112:115], v[148:151], v[196:199]
    ds_read_b64_tr_b16 v[44:45], v13 offset:40960
    v_mfma_f32_16x16x32_bf16 v[196:199], v[96:99], v[132:135], v[196:199]
    ds_read_b64_tr_b16 v[46:47], v13 offset:45056
    v_mfma_f32_16x16x32_bf16 v[212:215], v[100:103], v[132:135], v[212:215]
    ds_read_b64_tr_b16 v[32:33], v14 offset:32768
    v_mfma_f32_16x16x32_bf16 v[212:215], v[116:119], v[148:151], v[212:215]
    ds_read_b64_tr_b16 v[34:35], v14 offset:36864
    v_mfma_f32_16x16x32_bf16 v[208:211], v[116:119], v[144:147], v[208:211]
    ds_read_b64_tr_b16 v[48:49], v14 offset:40960
    v_mfma_f32_16x16x32_bf16 v[208:211], v[100:103], v[128:131], v[208:211]
    ds_read_b64_tr_b16 v[50:51], v14 offset:45056
    v_mfma_f32_16x16x32_bf16 v[204:207], v[100:103], v[124:127], v[204:207]
    ds_read_b64_tr_b16 v[36:37], v15 offset:32768
    v_mfma_f32_16x16x32_bf16 v[204:207], v[116:119], v[140:143], v[204:207]
    ds_read_b64_tr_b16 v[38:39], v15 offset:36864
    v_mfma_f32_16x16x32_bf16 v[200:203], v[116:119], v[136:139], v[200:203]
    ds_read_b64_tr_b16 v[52:53], v15 offset:40960
    v_mfma_f32_16x16x32_bf16 v[200:203], v[100:103], v[120:123], v[200:203]
    ds_read_b64_tr_b16 v[54:55], v15 offset:45056
    s_waitcnt lgkmcnt(7)
    v_mfma_f32_16x16x32_bf16 v[152:155], v[24:27], v[56:59], v[152:155]
    v_mfma_f32_16x16x32_bf16 v[152:155], v[40:43], v[72:75], v[152:155]
    v_mfma_f32_16x16x32_bf16 v[156:159], v[40:43], v[76:79], v[156:159]
    v_mfma_f32_16x16x32_bf16 v[156:159], v[24:27], v[60:63], v[156:159]
    v_mfma_f32_16x16x32_bf16 v[160:163], v[24:27], v[64:67], v[160:163]
    v_mfma_f32_16x16x32_bf16 v[160:163], v[40:43], v[80:83], v[160:163]
    v_mfma_f32_16x16x32_bf16 v[164:167], v[40:43], v[84:87], v[164:167]
    v_mfma_f32_16x16x32_bf16 v[164:167], v[24:27], v[68:71], v[164:167]
    s_waitcnt lgkmcnt(0)
    s_barrier
    v_mfma_f32_16x16x32_bf16 v[180:183], v[28:31], v[68:71], v[180:183]
    ds_read_b64_tr_b16 v[88:89], v8 offset:0
    v_mfma_f32_16x16x32_bf16 v[180:183], v[44:47], v[84:87], v[180:183]
    ds_read_b64_tr_b16 v[90:91], v8 offset:4096
    v_mfma_f32_16x16x32_bf16 v[176:179], v[44:47], v[80:83], v[176:179]
    ds_read_b128 v[120:123], v16 offset:0
    v_mfma_f32_16x16x32_bf16 v[176:179], v[28:31], v[64:67], v[176:179]
    ds_read_b64_tr_b16 v[104:105], v8 offset:8192
    v_mfma_f32_16x16x32_bf16 v[172:175], v[28:31], v[60:63], v[172:175]
    ds_read_b64_tr_b16 v[106:107], v8 offset:12288
    v_mfma_f32_16x16x32_bf16 v[172:175], v[44:47], v[76:79], v[172:175]
    ds_read_b128 v[136:139], v16 offset:8192
    v_mfma_f32_16x16x32_bf16 v[168:171], v[44:47], v[72:75], v[168:171]
    ds_read_b128 v[140:143], v17 offset:8192
    v_mfma_f32_16x16x32_bf16 v[168:171], v[28:31], v[56:59], v[168:171]
    ds_read_b128 v[124:127], v17 offset:0
    v_mfma_f32_16x16x32_bf16 v[184:187], v[32:35], v[56:59], v[184:187]
    ds_read_b128 v[128:131], v18 offset:0
    v_mfma_f32_16x16x32_bf16 v[184:187], v[48:51], v[72:75], v[184:187]
    ds_read_b128 v[144:147], v18 offset:8192
    v_mfma_f32_16x16x32_bf16 v[188:191], v[48:51], v[76:79], v[188:191]
    ds_read_b128 v[148:151], v19 offset:8192
    v_mfma_f32_16x16x32_bf16 v[188:191], v[32:35], v[60:63], v[188:191]
    ds_read_b128 v[132:135], v19 offset:0
    v_mfma_f32_16x16x32_bf16 v[192:195], v[32:35], v[64:67], v[192:195]
    ds_read_b64_tr_b16 v[92:93], v9 offset:0
    v_mfma_f32_16x16x32_bf16 v[192:195], v[48:51], v[80:83], v[192:195]
    ds_read_b64_tr_b16 v[94:95], v9 offset:4096
    v_mfma_f32_16x16x32_bf16 v[196:199], v[48:51], v[84:87], v[196:199]
    ds_read_b64_tr_b16 v[108:109], v9 offset:8192
    v_mfma_f32_16x16x32_bf16 v[196:199], v[32:35], v[68:71], v[196:199]
    ds_read_b64_tr_b16 v[110:111], v9 offset:12288
    v_mfma_f32_16x16x32_bf16 v[212:215], v[36:39], v[68:71], v[212:215]
    ds_read_b64_tr_b16 v[96:97], v10 offset:0
    v_mfma_f32_16x16x32_bf16 v[212:215], v[52:55], v[84:87], v[212:215]
    ds_read_b64_tr_b16 v[98:99], v10 offset:4096
    v_mfma_f32_16x16x32_bf16 v[208:211], v[52:55], v[80:83], v[208:211]
    ds_read_b64_tr_b16 v[112:113], v10 offset:8192
    v_mfma_f32_16x16x32_bf16 v[208:211], v[36:39], v[64:67], v[208:211]
    ds_read_b64_tr_b16 v[114:115], v10 offset:12288
    v_mfma_f32_16x16x32_bf16 v[204:207], v[36:39], v[60:63], v[204:207]
    ds_read_b64_tr_b16 v[100:101], v11 offset:0
    v_mfma_f32_16x16x32_bf16 v[204:207], v[52:55], v[76:79], v[204:207]
    ds_read_b64_tr_b16 v[102:103], v11 offset:4096
    v_mfma_f32_16x16x32_bf16 v[200:203], v[52:55], v[72:75], v[200:203]
    ds_read_b64_tr_b16 v[116:117], v11 offset:8192
    v_mfma_f32_16x16x32_bf16 v[200:203], v[36:39], v[56:59], v[200:203]
    ds_read_b64_tr_b16 v[118:119], v11 offset:12288
    s_waitcnt lgkmcnt(7)
    v_mfma_f32_16x16x32_bf16 v[152:155], v[88:91], v[120:123], v[152:155]
    v_mfma_f32_16x16x32_bf16 v[152:155], v[104:107], v[136:139], v[152:155]
    v_mfma_f32_16x16x32_bf16 v[156:159], v[104:107], v[140:143], v[156:159]
    v_mfma_f32_16x16x32_bf16 v[156:159], v[88:91], v[124:127], v[156:159]
    v_mfma_f32_16x16x32_bf16 v[160:163], v[88:91], v[128:131], v[160:163]
    v_mfma_f32_16x16x32_bf16 v[160:163], v[104:107], v[144:147], v[160:163]
    v_mfma_f32_16x16x32_bf16 v[164:167], v[104:107], v[148:151], v[164:167]
    v_mfma_f32_16x16x32_bf16 v[164:167], v[88:91], v[132:135], v[164:167]
    s_waitcnt lgkmcnt(0)
    s_barrier
    v_mfma_f32_16x16x32_bf16 v[180:183], v[92:95], v[132:135], v[180:183]
    ds_read_b64_tr_b16 v[24:25], v8 offset:16384
    v_mfma_f32_16x16x32_bf16 v[180:183], v[108:111], v[148:151], v[180:183]
    ds_read_b64_tr_b16 v[26:27], v8 offset:20480
    v_mfma_f32_16x16x32_bf16 v[176:179], v[108:111], v[144:147], v[176:179]
    ds_read_b128 v[56:59], v16 offset:16384
    v_mfma_f32_16x16x32_bf16 v[176:179], v[92:95], v[128:131], v[176:179]
    ds_read_b64_tr_b16 v[40:41], v8 offset:24576
    v_mfma_f32_16x16x32_bf16 v[172:175], v[92:95], v[124:127], v[172:175]
    ds_read_b64_tr_b16 v[42:43], v8 offset:28672
    v_mfma_f32_16x16x32_bf16 v[172:175], v[108:111], v[140:143], v[172:175]
    ds_read_b128 v[72:75], v16 offset:24576
    v_mfma_f32_16x16x32_bf16 v[168:171], v[108:111], v[136:139], v[168:171]
    ds_read_b128 v[76:79], v17 offset:24576
    v_mfma_f32_16x16x32_bf16 v[168:171], v[92:95], v[120:123], v[168:171]
    ds_read_b128 v[60:63], v17 offset:16384
    v_mfma_f32_16x16x32_bf16 v[184:187], v[96:99], v[120:123], v[184:187]
    ds_read_b128 v[64:67], v18 offset:16384
    v_mfma_f32_16x16x32_bf16 v[184:187], v[112:115], v[136:139], v[184:187]
    ds_read_b128 v[80:83], v18 offset:24576
    v_mfma_f32_16x16x32_bf16 v[188:191], v[112:115], v[140:143], v[188:191]
    ds_read_b128 v[84:87], v19 offset:24576
    v_mfma_f32_16x16x32_bf16 v[188:191], v[96:99], v[124:127], v[188:191]
    ds_read_b128 v[68:71], v19 offset:16384
    v_mfma_f32_16x16x32_bf16 v[192:195], v[96:99], v[128:131], v[192:195]
    ds_read_b64_tr_b16 v[28:29], v9 offset:16384
    v_mfma_f32_16x16x32_bf16 v[192:195], v[112:115], v[144:147], v[192:195]
    ds_read_b64_tr_b16 v[30:31], v9 offset:20480
    v_mfma_f32_16x16x32_bf16 v[196:199], v[112:115], v[148:151], v[196:199]
    ds_read_b64_tr_b16 v[44:45], v9 offset:24576
    v_mfma_f32_16x16x32_bf16 v[196:199], v[96:99], v[132:135], v[196:199]
    ds_read_b64_tr_b16 v[46:47], v9 offset:28672
    v_mfma_f32_16x16x32_bf16 v[212:215], v[100:103], v[132:135], v[212:215]
    ds_read_b64_tr_b16 v[32:33], v10 offset:16384
    v_mfma_f32_16x16x32_bf16 v[212:215], v[116:119], v[148:151], v[212:215]
    ds_read_b64_tr_b16 v[34:35], v10 offset:20480
    v_mfma_f32_16x16x32_bf16 v[208:211], v[116:119], v[144:147], v[208:211]
    ds_read_b64_tr_b16 v[48:49], v10 offset:24576
    v_mfma_f32_16x16x32_bf16 v[208:211], v[100:103], v[128:131], v[208:211]
    ds_read_b64_tr_b16 v[50:51], v10 offset:28672
    v_mfma_f32_16x16x32_bf16 v[204:207], v[100:103], v[124:127], v[204:207]
    ds_read_b64_tr_b16 v[36:37], v11 offset:16384
    v_mfma_f32_16x16x32_bf16 v[204:207], v[116:119], v[140:143], v[204:207]
    ds_read_b64_tr_b16 v[38:39], v11 offset:20480
    v_mfma_f32_16x16x32_bf16 v[200:203], v[116:119], v[136:139], v[200:203]
    ds_read_b64_tr_b16 v[52:53], v11 offset:24576
    v_mfma_f32_16x16x32_bf16 v[200:203], v[100:103], v[120:123], v[200:203]
    ds_read_b64_tr_b16 v[54:55], v11 offset:28672
    s_waitcnt lgkmcnt(7)
    v_mfma_f32_16x16x32_bf16 v[152:155], v[24:27], v[56:59], v[152:155]
    v_mfma_f32_16x16x32_bf16 v[152:155], v[40:43], v[72:75], v[152:155]
    v_mfma_f32_16x16x32_bf16 v[156:159], v[40:43], v[76:79], v[156:159]
    v_mfma_f32_16x16x32_bf16 v[156:159], v[24:27], v[60:63], v[156:159]
    v_mfma_f32_16x16x32_bf16 v[160:163], v[24:27], v[64:67], v[160:163]
    v_mfma_f32_16x16x32_bf16 v[160:163], v[40:43], v[80:83], v[160:163]
    v_mfma_f32_16x16x32_bf16 v[164:167], v[40:43], v[84:87], v[164:167]
    v_mfma_f32_16x16x32_bf16 v[164:167], v[24:27], v[68:71], v[164:167]
    s_waitcnt lgkmcnt(0)
    s_barrier
    v_mfma_f32_16x16x32_bf16 v[180:183], v[28:31], v[68:71], v[180:183]
    ds_read_b64_tr_b16 v[88:89], v8 offset:49152
    v_mfma_f32_16x16x32_bf16 v[180:183], v[44:47], v[84:87], v[180:183]
    ds_read_b64_tr_b16 v[90:91], v8 offset:53248
    v_mfma_f32_16x16x32_bf16 v[176:179], v[44:47], v[80:83], v[176:179]
    ds_read_b128 v[120:123], v16 offset:32768
    v_mfma_f32_16x16x32_bf16 v[176:179], v[28:31], v[64:67], v[176:179]
    ds_read_b64_tr_b16 v[104:105], v8 offset:57344
    v_mfma_f32_16x16x32_bf16 v[172:175], v[28:31], v[60:63], v[172:175]
    ds_read_b64_tr_b16 v[106:107], v8 offset:61440
    v_mfma_f32_16x16x32_bf16 v[172:175], v[44:47], v[76:79], v[172:175]
    ds_read_b128 v[136:139], v16 offset:40960
    v_mfma_f32_16x16x32_bf16 v[168:171], v[44:47], v[72:75], v[168:171]
    ds_read_b128 v[140:143], v17 offset:40960
    v_mfma_f32_16x16x32_bf16 v[168:171], v[28:31], v[56:59], v[168:171]
    ds_read_b128 v[124:127], v17 offset:32768
    v_mfma_f32_16x16x32_bf16 v[184:187], v[32:35], v[56:59], v[184:187]
    ds_read_b128 v[128:131], v18 offset:32768
    v_mfma_f32_16x16x32_bf16 v[184:187], v[48:51], v[72:75], v[184:187]
    ds_read_b128 v[144:147], v18 offset:40960
    v_mfma_f32_16x16x32_bf16 v[188:191], v[48:51], v[76:79], v[188:191]
    ds_read_b128 v[148:151], v19 offset:40960
    v_mfma_f32_16x16x32_bf16 v[188:191], v[32:35], v[60:63], v[188:191]
    ds_read_b128 v[132:135], v19 offset:32768
    v_mfma_f32_16x16x32_bf16 v[192:195], v[32:35], v[64:67], v[192:195]
    ds_read_b64_tr_b16 v[92:93], v9 offset:49152
    v_mfma_f32_16x16x32_bf16 v[192:195], v[48:51], v[80:83], v[192:195]
    ds_read_b64_tr_b16 v[94:95], v9 offset:53248
    v_mfma_f32_16x16x32_bf16 v[196:199], v[48:51], v[84:87], v[196:199]
    ds_read_b64_tr_b16 v[108:109], v9 offset:57344
    v_mfma_f32_16x16x32_bf16 v[196:199], v[32:35], v[68:71], v[196:199]
    ds_read_b64_tr_b16 v[110:111], v9 offset:61440
    v_mfma_f32_16x16x32_bf16 v[212:215], v[36:39], v[68:71], v[212:215]
    ds_read_b64_tr_b16 v[96:97], v10 offset:49152
    v_mfma_f32_16x16x32_bf16 v[212:215], v[52:55], v[84:87], v[212:215]
    ds_read_b64_tr_b16 v[98:99], v10 offset:53248
    v_mfma_f32_16x16x32_bf16 v[208:211], v[52:55], v[80:83], v[208:211]
    ds_read_b64_tr_b16 v[112:113], v10 offset:57344
    v_mfma_f32_16x16x32_bf16 v[208:211], v[36:39], v[64:67], v[208:211]
    ds_read_b64_tr_b16 v[114:115], v10 offset:61440
    v_mfma_f32_16x16x32_bf16 v[204:207], v[36:39], v[60:63], v[204:207]
    ds_read_b64_tr_b16 v[100:101], v11 offset:49152
    v_mfma_f32_16x16x32_bf16 v[204:207], v[52:55], v[76:79], v[204:207]
    ds_read_b64_tr_b16 v[102:103], v11 offset:53248
    v_mfma_f32_16x16x32_bf16 v[200:203], v[52:55], v[72:75], v[200:203]
    ds_read_b64_tr_b16 v[116:117], v11 offset:57344
    v_mfma_f32_16x16x32_bf16 v[200:203], v[36:39], v[56:59], v[200:203]
    ds_read_b64_tr_b16 v[118:119], v11 offset:61440
    s_waitcnt lgkmcnt(7)
    v_mfma_f32_16x16x32_bf16 v[152:155], v[88:91], v[120:123], v[152:155]
    v_mfma_f32_16x16x32_bf16 v[152:155], v[104:107], v[136:139], v[152:155]
    v_mfma_f32_16x16x32_bf16 v[156:159], v[104:107], v[140:143], v[156:159]
    v_mfma_f32_16x16x32_bf16 v[156:159], v[88:91], v[124:127], v[156:159]
    v_mfma_f32_16x16x32_bf16 v[160:163], v[88:91], v[128:131], v[160:163]
    v_mfma_f32_16x16x32_bf16 v[160:163], v[104:107], v[144:147], v[160:163]
    v_mfma_f32_16x16x32_bf16 v[164:167], v[104:107], v[148:151], v[164:167]
    v_mfma_f32_16x16x32_bf16 v[164:167], v[88:91], v[132:135], v[164:167]
    s_waitcnt lgkmcnt(0)
    s_barrier
    v_mfma_f32_16x16x32_bf16 v[180:183], v[92:95], v[132:135], v[180:183]
    ds_read_b64_tr_b16 v[24:25], v12 offset:0
    v_mfma_f32_16x16x32_bf16 v[180:183], v[108:111], v[148:151], v[180:183]
    ds_read_b64_tr_b16 v[26:27], v12 offset:4096
    v_mfma_f32_16x16x32_bf16 v[176:179], v[108:111], v[144:147], v[176:179]
    ds_read_b128 v[56:59], v16 offset:0
    v_mfma_f32_16x16x32_bf16 v[176:179], v[92:95], v[128:131], v[176:179]
    ds_read_b64_tr_b16 v[40:41], v12 offset:8192
    v_mfma_f32_16x16x32_bf16 v[172:175], v[92:95], v[124:127], v[172:175]
    ds_read_b64_tr_b16 v[42:43], v12 offset:12288
    v_mfma_f32_16x16x32_bf16 v[172:175], v[108:111], v[140:143], v[172:175]
    ds_read_b128 v[72:75], v16 offset:8192
    v_mfma_f32_16x16x32_bf16 v[168:171], v[108:111], v[136:139], v[168:171]
    ds_read_b128 v[76:79], v17 offset:8192
    v_mfma_f32_16x16x32_bf16 v[168:171], v[92:95], v[120:123], v[168:171]
    ds_read_b128 v[60:63], v17 offset:0
    v_mfma_f32_16x16x32_bf16 v[184:187], v[96:99], v[120:123], v[184:187]
    ds_read_b128 v[64:67], v18 offset:0
    v_mfma_f32_16x16x32_bf16 v[184:187], v[112:115], v[136:139], v[184:187]
    ds_read_b128 v[80:83], v18 offset:8192
    v_mfma_f32_16x16x32_bf16 v[188:191], v[112:115], v[140:143], v[188:191]
    ds_read_b128 v[84:87], v19 offset:8192
    v_mfma_f32_16x16x32_bf16 v[188:191], v[96:99], v[124:127], v[188:191]
    ds_read_b128 v[68:71], v19 offset:0
    v_mfma_f32_16x16x32_bf16 v[192:195], v[96:99], v[128:131], v[192:195]
    ds_read_b64_tr_b16 v[28:29], v13 offset:0
    v_mfma_f32_16x16x32_bf16 v[192:195], v[112:115], v[144:147], v[192:195]
    ds_read_b64_tr_b16 v[30:31], v13 offset:4096
    v_mfma_f32_16x16x32_bf16 v[196:199], v[112:115], v[148:151], v[196:199]
    ds_read_b64_tr_b16 v[44:45], v13 offset:8192
    v_mfma_f32_16x16x32_bf16 v[196:199], v[96:99], v[132:135], v[196:199]
    ds_read_b64_tr_b16 v[46:47], v13 offset:12288
    v_mfma_f32_16x16x32_bf16 v[212:215], v[100:103], v[132:135], v[212:215]
    ds_read_b64_tr_b16 v[32:33], v14 offset:0
    v_mfma_f32_16x16x32_bf16 v[212:215], v[116:119], v[148:151], v[212:215]
    ds_read_b64_tr_b16 v[34:35], v14 offset:4096
    v_mfma_f32_16x16x32_bf16 v[208:211], v[116:119], v[144:147], v[208:211]
    ds_read_b64_tr_b16 v[48:49], v14 offset:8192
    v_mfma_f32_16x16x32_bf16 v[208:211], v[100:103], v[128:131], v[208:211]
    ds_read_b64_tr_b16 v[50:51], v14 offset:12288
    v_mfma_f32_16x16x32_bf16 v[204:207], v[100:103], v[124:127], v[204:207]
    ds_read_b64_tr_b16 v[36:37], v15 offset:0
    v_mfma_f32_16x16x32_bf16 v[204:207], v[116:119], v[140:143], v[204:207]
    ds_read_b64_tr_b16 v[38:39], v15 offset:4096
    v_mfma_f32_16x16x32_bf16 v[200:203], v[116:119], v[136:139], v[200:203]
    ds_read_b64_tr_b16 v[52:53], v15 offset:8192
    v_mfma_f32_16x16x32_bf16 v[200:203], v[100:103], v[120:123], v[200:203]
    ds_read_b64_tr_b16 v[54:55], v15 offset:12288
    s_waitcnt lgkmcnt(7)
    v_mfma_f32_16x16x32_bf16 v[152:155], v[24:27], v[56:59], v[152:155]
    v_mfma_f32_16x16x32_bf16 v[152:155], v[40:43], v[72:75], v[152:155]
    v_mfma_f32_16x16x32_bf16 v[156:159], v[40:43], v[76:79], v[156:159]
    v_mfma_f32_16x16x32_bf16 v[156:159], v[24:27], v[60:63], v[156:159]
    v_mfma_f32_16x16x32_bf16 v[160:163], v[24:27], v[64:67], v[160:163]
    v_mfma_f32_16x16x32_bf16 v[160:163], v[40:43], v[80:83], v[160:163]
    v_mfma_f32_16x16x32_bf16 v[164:167], v[40:43], v[84:87], v[164:167]
    v_mfma_f32_16x16x32_bf16 v[164:167], v[24:27], v[68:71], v[164:167]
    s_waitcnt lgkmcnt(0)
    s_barrier
    v_mfma_f32_16x16x32_bf16 v[180:183], v[28:31], v[68:71], v[180:183]
    ds_read_b64_tr_b16 v[88:89], v12 offset:16384
    v_mfma_f32_16x16x32_bf16 v[180:183], v[44:47], v[84:87], v[180:183]
    ds_read_b64_tr_b16 v[90:91], v12 offset:20480
    v_mfma_f32_16x16x32_bf16 v[176:179], v[44:47], v[80:83], v[176:179]
    ds_read_b128 v[120:123], v16 offset:16384
    v_mfma_f32_16x16x32_bf16 v[176:179], v[28:31], v[64:67], v[176:179]
    ds_read_b64_tr_b16 v[104:105], v12 offset:24576
    v_mfma_f32_16x16x32_bf16 v[172:175], v[28:31], v[60:63], v[172:175]
    ds_read_b64_tr_b16 v[106:107], v12 offset:28672
    v_mfma_f32_16x16x32_bf16 v[172:175], v[44:47], v[76:79], v[172:175]
    ds_read_b128 v[136:139], v16 offset:24576
    v_mfma_f32_16x16x32_bf16 v[168:171], v[44:47], v[72:75], v[168:171]
    ds_read_b128 v[140:143], v17 offset:24576
    v_mfma_f32_16x16x32_bf16 v[168:171], v[28:31], v[56:59], v[168:171]
    ds_read_b128 v[124:127], v17 offset:16384
    v_mfma_f32_16x16x32_bf16 v[184:187], v[32:35], v[56:59], v[184:187]
    ds_read_b128 v[128:131], v18 offset:16384
    v_mfma_f32_16x16x32_bf16 v[184:187], v[48:51], v[72:75], v[184:187]
    ds_read_b128 v[144:147], v18 offset:24576
    v_mfma_f32_16x16x32_bf16 v[188:191], v[48:51], v[76:79], v[188:191]
    ds_read_b128 v[148:151], v19 offset:24576
    v_mfma_f32_16x16x32_bf16 v[188:191], v[32:35], v[60:63], v[188:191]
    ds_read_b128 v[132:135], v19 offset:16384
    v_mfma_f32_16x16x32_bf16 v[192:195], v[32:35], v[64:67], v[192:195]
    ds_read_b64_tr_b16 v[92:93], v13 offset:16384
    v_mfma_f32_16x16x32_bf16 v[192:195], v[48:51], v[80:83], v[192:195]
    ds_read_b64_tr_b16 v[94:95], v13 offset:20480
    v_mfma_f32_16x16x32_bf16 v[196:199], v[48:51], v[84:87], v[196:199]
    ds_read_b64_tr_b16 v[108:109], v13 offset:24576
    v_mfma_f32_16x16x32_bf16 v[196:199], v[32:35], v[68:71], v[196:199]
    ds_read_b64_tr_b16 v[110:111], v13 offset:28672
    v_mfma_f32_16x16x32_bf16 v[212:215], v[36:39], v[68:71], v[212:215]
    ds_read_b64_tr_b16 v[96:97], v14 offset:16384
    v_mfma_f32_16x16x32_bf16 v[212:215], v[52:55], v[84:87], v[212:215]
    ds_read_b64_tr_b16 v[98:99], v14 offset:20480
    v_mfma_f32_16x16x32_bf16 v[208:211], v[52:55], v[80:83], v[208:211]
    ds_read_b64_tr_b16 v[112:113], v14 offset:24576
    v_mfma_f32_16x16x32_bf16 v[208:211], v[36:39], v[64:67], v[208:211]
    ds_read_b64_tr_b16 v[114:115], v14 offset:28672
    v_mfma_f32_16x16x32_bf16 v[204:207], v[36:39], v[60:63], v[204:207]
    ds_read_b64_tr_b16 v[100:101], v15 offset:16384
    v_mfma_f32_16x16x32_bf16 v[204:207], v[52:55], v[76:79], v[204:207]
    ds_read_b64_tr_b16 v[102:103], v15 offset:20480
    v_mfma_f32_16x16x32_bf16 v[200:203], v[52:55], v[72:75], v[200:203]
    ds_read_b64_tr_b16 v[116:117], v15 offset:24576
    v_mfma_f32_16x16x32_bf16 v[200:203], v[36:39], v[56:59], v[200:203]
    ds_read_b64_tr_b16 v[118:119], v15 offset:28672
    s_waitcnt lgkmcnt(7)
    v_mfma_f32_16x16x32_bf16 v[152:155], v[88:91], v[120:123], v[152:155]
    v_mfma_f32_16x16x32_bf16 v[152:155], v[104:107], v[136:139], v[152:155]
    v_mfma_f32_16x16x32_bf16 v[156:159], v[104:107], v[140:143], v[156:159]
    v_mfma_f32_16x16x32_bf16 v[156:159], v[88:91], v[124:127], v[156:159]
    v_mfma_f32_16x16x32_bf16 v[160:163], v[88:91], v[128:131], v[160:163]
    v_mfma_f32_16x16x32_bf16 v[160:163], v[104:107], v[144:147], v[160:163]
    v_mfma_f32_16x16x32_bf16 v[164:167], v[104:107], v[148:151], v[164:167]
    v_mfma_f32_16x16x32_bf16 v[164:167], v[88:91], v[132:135], v[164:167]
    s_waitcnt lgkmcnt(0)
    s_barrier
    v_mfma_f32_16x16x32_bf16 v[180:183], v[92:95], v[132:135], v[180:183]
    ds_read_b64_tr_b16 v[24:25], v8 offset:32768
    v_mfma_f32_16x16x32_bf16 v[180:183], v[108:111], v[148:151], v[180:183]
    ds_read_b64_tr_b16 v[26:27], v8 offset:36864
    v_mfma_f32_16x16x32_bf16 v[176:179], v[108:111], v[144:147], v[176:179]
    ds_read_b128 v[56:59], v16 offset:32768
    v_mfma_f32_16x16x32_bf16 v[176:179], v[92:95], v[128:131], v[176:179]
    ds_read_b64_tr_b16 v[40:41], v8 offset:40960
    v_mfma_f32_16x16x32_bf16 v[172:175], v[92:95], v[124:127], v[172:175]
    ds_read_b64_tr_b16 v[42:43], v8 offset:45056
    v_mfma_f32_16x16x32_bf16 v[172:175], v[108:111], v[140:143], v[172:175]
    ds_read_b128 v[72:75], v16 offset:40960
    v_mfma_f32_16x16x32_bf16 v[168:171], v[108:111], v[136:139], v[168:171]
    ds_read_b128 v[76:79], v17 offset:40960
    v_mfma_f32_16x16x32_bf16 v[168:171], v[92:95], v[120:123], v[168:171]
    ds_read_b128 v[60:63], v17 offset:32768
    v_mfma_f32_16x16x32_bf16 v[184:187], v[96:99], v[120:123], v[184:187]
    ds_read_b128 v[64:67], v18 offset:32768
    v_mfma_f32_16x16x32_bf16 v[184:187], v[112:115], v[136:139], v[184:187]
    ds_read_b128 v[80:83], v18 offset:40960
    v_mfma_f32_16x16x32_bf16 v[188:191], v[112:115], v[140:143], v[188:191]
    ds_read_b128 v[84:87], v19 offset:40960
    v_mfma_f32_16x16x32_bf16 v[188:191], v[96:99], v[124:127], v[188:191]
    ds_read_b128 v[68:71], v19 offset:32768
    v_mfma_f32_16x16x32_bf16 v[192:195], v[96:99], v[128:131], v[192:195]
    ds_read_b64_tr_b16 v[28:29], v9 offset:32768
    v_mfma_f32_16x16x32_bf16 v[192:195], v[112:115], v[144:147], v[192:195]
    ds_read_b64_tr_b16 v[30:31], v9 offset:36864
    v_mfma_f32_16x16x32_bf16 v[196:199], v[112:115], v[148:151], v[196:199]
    ds_read_b64_tr_b16 v[44:45], v9 offset:40960
    v_mfma_f32_16x16x32_bf16 v[196:199], v[96:99], v[132:135], v[196:199]
    ds_read_b64_tr_b16 v[46:47], v9 offset:45056
    v_mfma_f32_16x16x32_bf16 v[212:215], v[100:103], v[132:135], v[212:215]
    ds_read_b64_tr_b16 v[32:33], v10 offset:32768
    v_mfma_f32_16x16x32_bf16 v[212:215], v[116:119], v[148:151], v[212:215]
    ds_read_b64_tr_b16 v[34:35], v10 offset:36864
    v_mfma_f32_16x16x32_bf16 v[208:211], v[116:119], v[144:147], v[208:211]
    ds_read_b64_tr_b16 v[48:49], v10 offset:40960
    v_mfma_f32_16x16x32_bf16 v[208:211], v[100:103], v[128:131], v[208:211]
    ds_read_b64_tr_b16 v[50:51], v10 offset:45056
    v_mfma_f32_16x16x32_bf16 v[204:207], v[100:103], v[124:127], v[204:207]
    ds_read_b64_tr_b16 v[36:37], v11 offset:32768
    v_mfma_f32_16x16x32_bf16 v[204:207], v[116:119], v[140:143], v[204:207]
    ds_read_b64_tr_b16 v[38:39], v11 offset:36864
    v_mfma_f32_16x16x32_bf16 v[200:203], v[116:119], v[136:139], v[200:203]
    ds_read_b64_tr_b16 v[52:53], v11 offset:40960
    v_mfma_f32_16x16x32_bf16 v[200:203], v[100:103], v[120:123], v[200:203]
    ds_read_b64_tr_b16 v[54:55], v11 offset:45056
    s_barrier
    s_waitcnt lgkmcnt(6)
    v_mfma_f32_16x16x32_bf16 v[152:155], v[24:27], v[56:59], v[152:155]
    ds_read_b128 v[120:123], v16 offset:0
    v_mfma_f32_16x16x32_bf16 v[152:155], v[40:43], v[72:75], v[152:155]
    ds_read_b64_tr_b16 v[88:89], v12 offset:32768
    v_mfma_f32_16x16x32_bf16 v[156:159], v[40:43], v[76:79], v[156:159]
    ds_read_b64_tr_b16 v[90:91], v12 offset:36864
    v_mfma_f32_16x16x32_bf16 v[156:159], v[24:27], v[60:63], v[156:159]
    ds_read_b128 v[136:139], v16 offset:8192
    v_mfma_f32_16x16x32_bf16 v[160:163], v[24:27], v[64:67], v[160:163]
    ds_read_b64_tr_b16 v[104:105], v12 offset:40960
    v_mfma_f32_16x16x32_bf16 v[160:163], v[40:43], v[80:83], v[160:163]
    ds_read_b64_tr_b16 v[106:107], v12 offset:45056
    v_mfma_f32_16x16x32_bf16 v[176:179], v[44:47], v[80:83], v[176:179]
    ds_read_b64_tr_b16 v[92:93], v13 offset:32768
    v_mfma_f32_16x16x32_bf16 v[176:179], v[28:31], v[64:67], v[176:179]
    ds_read_b64_tr_b16 v[94:95], v13 offset:36864
    v_mfma_f32_16x16x32_bf16 v[172:175], v[28:31], v[60:63], v[172:175]
    ds_read_b64_tr_b16 v[108:109], v13 offset:40960
    v_mfma_f32_16x16x32_bf16 v[172:175], v[44:47], v[76:79], v[172:175]
    ds_read_b64_tr_b16 v[110:111], v13 offset:45056
    v_mfma_f32_16x16x32_bf16 v[168:171], v[44:47], v[72:75], v[168:171]
    ds_read_b64_tr_b16 v[96:97], v14 offset:32768
    v_mfma_f32_16x16x32_bf16 v[168:171], v[28:31], v[56:59], v[168:171]
    ds_read_b64_tr_b16 v[98:99], v14 offset:36864
    v_mfma_f32_16x16x32_bf16 v[184:187], v[32:35], v[56:59], v[184:187]
    ds_read_b64_tr_b16 v[112:113], v14 offset:40960
    s_waitcnt lgkmcnt(7)
    v_mfma_f32_16x16x32_bf16 v[184:187], v[48:51], v[72:75], v[184:187]
    ds_read_b64_tr_b16 v[114:115], v14 offset:45056
    v_mfma_f32_16x16x32_bf16 v[188:191], v[48:51], v[76:79], v[188:191]
    ds_read_b64_tr_b16 v[100:101], v15 offset:32768
    v_mfma_f32_16x16x32_bf16 v[188:191], v[32:35], v[60:63], v[188:191]
    ds_read_b64_tr_b16 v[102:103], v15 offset:36864
    v_mfma_f32_16x16x32_bf16 v[192:195], v[32:35], v[64:67], v[192:195]
    ds_read_b64_tr_b16 v[116:117], v15 offset:40960
    v_mfma_f32_16x16x32_bf16 v[192:195], v[48:51], v[80:83], v[192:195]
    ds_read_b64_tr_b16 v[118:119], v15 offset:45056
    v_mfma_f32_16x16x32_bf16 v[208:211], v[52:55], v[80:83], v[208:211]
    ds_read_b128 v[124:127], v17 offset:0
    v_mfma_f32_16x16x32_bf16 v[208:211], v[36:39], v[64:67], v[208:211]
    ds_read_b128 v[140:143], v17 offset:8192
    v_mfma_f32_16x16x32_bf16 v[204:207], v[36:39], v[60:63], v[204:207]
    ds_read_b128 v[128:131], v18 offset:0
    v_mfma_f32_16x16x32_bf16 v[204:207], v[52:55], v[76:79], v[204:207]
    ds_read_b128 v[144:147], v18 offset:8192
    v_mfma_f32_16x16x32_bf16 v[200:203], v[52:55], v[72:75], v[200:203]
    ds_read_b128 v[132:135], v19 offset:0
    v_mfma_f32_16x16x32_bf16 v[200:203], v[36:39], v[56:59], v[200:203]
    ds_read_b128 v[148:151], v19 offset:8192
    v_mfma_f32_16x16x32_bf16 v[152:155], v[88:91], v[120:123], v[152:155]
    v_mfma_f32_16x16x32_bf16 v[152:155], v[104:107], v[136:139], v[152:155]
    s_waitcnt lgkmcnt(6)
    v_mfma_f32_16x16x32_bf16 v[168:171], v[108:111], v[136:139], v[168:171]
    v_mfma_f32_16x16x32_bf16 v[168:171], v[92:95], v[120:123], v[168:171]
    v_mfma_f32_16x16x32_bf16 v[184:187], v[96:99], v[120:123], v[184:187]
    s_nop 3
    v_cvt_pk_bf16_f32 v152, v152, v153
    v_cvt_pk_bf16_f32 v153, v154, v155
    v_mfma_f32_16x16x32_bf16 v[184:187], v[112:115], v[136:139], v[184:187]
    v_mfma_f32_16x16x32_bf16 v[200:203], v[116:119], v[136:139], v[200:203]
    v_cvt_pk_bf16_f32 v154, v168, v169
    v_cvt_pk_bf16_f32 v155, v170, v171
    v_mfma_f32_16x16x32_bf16 v[200:203], v[100:103], v[120:123], v[200:203]
    buffer_store_dwordx4 v[152:155], v22, s[56:59], s14 offen offset:0 sc1
    s_waitcnt lgkmcnt(0)
    v_mfma_f32_16x16x32_bf16 v[204:207], v[100:103], v[124:127], v[204:207]
    s_nop 0
    v_cvt_pk_bf16_f32 v184, v184, v185
    v_cvt_pk_bf16_f32 v185, v186, v187
    v_mfma_f32_16x16x32_bf16 v[204:207], v[116:119], v[140:143], v[204:207]
    s_nop 0
    v_cvt_pk_bf16_f32 v186, v200, v201
    v_cvt_pk_bf16_f32 v187, v202, v203
    v_mfma_f32_16x16x32_bf16 v[188:191], v[112:115], v[140:143], v[188:191]
    buffer_store_dwordx4 v[184:187], v22, s[56:59], s14 offen offset:1024 sc1
    v_mfma_f32_16x16x32_bf16 v[188:191], v[96:99], v[124:127], v[188:191]
    v_mfma_f32_16x16x32_bf16 v[172:175], v[92:95], v[124:127], v[172:175]
    v_mfma_f32_16x16x32_bf16 v[172:175], v[108:111], v[140:143], v[172:175]
    v_mfma_f32_16x16x32_bf16 v[156:159], v[104:107], v[140:143], v[156:159]
    s_nop 4
    v_cvt_pk_bf16_f32 v188, v188, v189
    v_cvt_pk_bf16_f32 v189, v190, v191
    v_mfma_f32_16x16x32_bf16 v[156:159], v[88:91], v[124:127], v[156:159]
    v_cvt_pk_bf16_f32 v190, v204, v205
    v_cvt_pk_bf16_f32 v191, v206, v207
    v_mfma_f32_16x16x32_bf16 v[160:163], v[88:91], v[128:131], v[160:163]
    buffer_store_dwordx4 v[188:191], v22, s[56:59], s15 offen offset:1024 sc1
    v_mfma_f32_16x16x32_bf16 v[160:163], v[104:107], v[144:147], v[160:163]
    s_nop 2
    v_cvt_pk_bf16_f32 v156, v156, v157
    v_cvt_pk_bf16_f32 v157, v158, v159
    v_mfma_f32_16x16x32_bf16 v[176:179], v[108:111], v[144:147], v[176:179]
    v_cvt_pk_bf16_f32 v158, v172, v173
    v_cvt_pk_bf16_f32 v159, v174, v175
    v_mfma_f32_16x16x32_bf16 v[176:179], v[92:95], v[128:131], v[176:179]
    buffer_store_dwordx4 v[156:159], v22, s[56:59], s15 offen offset:0 sc1
    v_mfma_f32_16x16x32_bf16 v[192:195], v[96:99], v[128:131], v[192:195]
    v_cvt_pk_bf16_f32 v160, v160, v161
    v_cvt_pk_bf16_f32 v161, v162, v163
    v_mfma_f32_16x16x32_bf16 v[192:195], v[112:115], v[144:147], v[192:195]
    s_nop 2
    v_cvt_pk_bf16_f32 v162, v176, v177
    v_cvt_pk_bf16_f32 v163, v178, v179
    v_mfma_f32_16x16x32_bf16 v[208:211], v[116:119], v[144:147], v[208:211]
    buffer_store_dwordx4 v[160:163], v22, s[56:59], s16 offen offset:0 sc1
    v_mfma_f32_16x16x32_bf16 v[208:211], v[100:103], v[128:131], v[208:211]
    v_cvt_pk_bf16_f32 v192, v192, v193
    v_cvt_pk_bf16_f32 v193, v194, v195
    v_mfma_f32_16x16x32_bf16 v[212:215], v[100:103], v[132:135], v[212:215]
    v_mfma_f32_16x16x32_bf16 v[212:215], v[116:119], v[148:151], v[212:215]
    v_mfma_f32_16x16x32_bf16 v[212:215], v[36:39], v[68:71], v[212:215]
    s_nop 2
    v_cvt_pk_bf16_f32 v194, v208, v209
    v_cvt_pk_bf16_f32 v195, v210, v211
    v_mfma_f32_16x16x32_bf16 v[212:215], v[52:55], v[84:87], v[212:215]
    buffer_store_dwordx4 v[192:195], v22, s[56:59], s16 offen offset:1024 sc1
    v_mfma_f32_16x16x32_bf16 v[196:199], v[96:99], v[132:135], v[196:199]
    v_mfma_f32_16x16x32_bf16 v[196:199], v[112:115], v[148:151], v[196:199]
    v_mfma_f32_16x16x32_bf16 v[196:199], v[32:35], v[68:71], v[196:199]
    v_mfma_f32_16x16x32_bf16 v[196:199], v[48:51], v[84:87], v[196:199]
    v_mfma_f32_16x16x32_bf16 v[180:183], v[92:95], v[132:135], v[180:183]
    v_mfma_f32_16x16x32_bf16 v[180:183], v[108:111], v[148:151], v[180:183]
    v_mfma_f32_16x16x32_bf16 v[180:183], v[28:31], v[68:71], v[180:183]
    v_mfma_f32_16x16x32_bf16 v[180:183], v[44:47], v[84:87], v[180:183]
    v_mfma_f32_16x16x32_bf16 v[164:167], v[88:91], v[132:135], v[164:167]
    v_mfma_f32_16x16x32_bf16 v[164:167], v[104:107], v[148:151], v[164:167]
    v_mfma_f32_16x16x32_bf16 v[164:167], v[24:27], v[68:71], v[164:167]
    v_mfma_f32_16x16x32_bf16 v[164:167], v[40:43], v[84:87], v[164:167]
    s_mov_b64 exec, s[20:21]
    s_waitcnt vmcnt(0)
    buffer_store_dword v6, v23, s[56:59], s33 offen sc1
    buffer_load_dword v7, v20, s[56:59], s11 offen sc1
    s_mov_b32 s92, 262144
L_f2:
    s_waitcnt vmcnt(0)
    v_cmp_ne_u32 vcc, 1, v7
    s_sub_u32 s92, s92, 1
    s_cbranch_scc1 L_f2_ok
    s_nop 1
    s_cbranch_vccz L_f2_ok
    buffer_load_dword v7, v20, s[56:59], s11 offen sc1
    s_waitcnt vmcnt(0)
    s_branch L_f2
L_f2_ok:
    s_mov_b64 exec, -1
    buffer_load_dwordx4 v[24:27], v22, s[56:59], s17 offen offset:0 sc1
    buffer_load_dwordx4 v[28:31], v22, s[56:59], s17 offen offset:1024 sc1
    buffer_load_dwordx4 v[32:35], v22, s[56:59], s18 offen offset:0 sc1
    buffer_load_dwordx4 v[36:39], v22, s[56:59], s18 offen offset:1024 sc1
    buffer_load_dwordx4 v[40:43], v22, s[56:59], s19 offen offset:0 sc1
    buffer_load_dwordx4 v[44:47], v22, s[56:59], s19 offen offset:1024 sc1
    s_mov_b32 s86, 0xffff0000
    s_lshl_b32 s87, s37, 12
    s_add_u32 s89, s88, 20480
    v_mul_u32_u24 v8, 144, v4
    v_lshl_add_u32 v8, v3, 3, v8
    v_add_u32 v8, s87, v8
    v_lshrrev_b32 v10, 3, v0
    v_and_b32 v11, 7, v0
    v_lshlrev_b32 v11, 4, v11
    v_mul_u32_u24 v9, 144, v10
    v_add3_u32 v9, v9, v11, s87
    v_mul_u32_u24 v10, 2560, v10
    v_add_u32 v10, v10, v11
    s_nop 0
    s_waitcnt vmcnt(5)
    v_lshlrev_b32 v56, 16, v24
    v_and_b32_e64 v57, s86, v24
    v_pk_add_f32 v[164:165], v[164:165], v[56:57]
    v_lshlrev_b32 v58, 16, v25
    v_and_b32 v59, s86, v25
    v_pk_add_f32 v[166:167], v[166:167], v[58:59]
    v_lshlrev_b32 v56, 16, v26
    v_and_b32 v57, s86, v26
    v_pk_add_f32 v[180:181], v[180:181], v[56:57]
    v_lshlrev_b32 v58, 16, v27
    v_and_b32 v59, s86, v27
    v_pk_add_f32 v[182:183], v[182:183], v[58:59]
    s_waitcnt vmcnt(4)
    v_lshlrev_b32 v56, 16, v28
    v_and_b32_e64 v57, s86, v28
    v_pk_add_f32 v[196:197], v[196:197], v[56:57]
    v_lshlrev_b32 v58, 16, v29
    v_and_b32 v59, s86, v29
    v_pk_add_f32 v[198:199], v[198:199], v[58:59]
    v_lshlrev_b32 v56, 16, v30
    v_and_b32 v57, s86, v30
    v_pk_add_f32 v[212:213], v[212:213], v[56:57]
    v_lshlrev_b32 v58, 16, v31
    v_and_b32 v59, s86, v31
    v_pk_add_f32 v[214:215], v[214:215], v[58:59]
    s_waitcnt vmcnt(3)
    v_lshlrev_b32 v56, 16, v32
    v_and_b32_e64 v57, s86, v32
    v_pk_add_f32 v[164:165], v[164:165], v[56:57]
    v_lshlrev_b32 v58, 16, v33
    v_and_b32 v59, s86, v33
    v_pk_add_f32 v[166:167], v[166:167], v[58:59]
    v_lshlrev_b32 v56, 16, v34
    v_and_b32 v57, s86, v34
    v_pk_add_f32 v[180:181], v[180:181], v[56:57]
    v_lshlrev_b32 v58, 16, v35
    v_and_b32 v59, s86, v35
    v_pk_add_f32 v[182:183], v[182:183], v[58:59]
    s_waitcnt vmcnt(2)
    v_lshlrev_b32 v56, 16, v36
    v_and_b32_e64 v57, s86, v36
    v_pk_add_f32 v[196:197], v[196:197], v[56:57]
    v_lshlrev_b32 v58, 16, v37
    v_and_b32 v59, s86, v37
    v_pk_add_f32 v[198:199], v[198:199], v[58:59]
    v_lshlrev_b32 v56, 16, v38
    v_and_b32 v57, s86, v38
    v_pk_add_f32 v[212:213], v[212:213], v[56:57]
    v_lshlrev_b32 v58, 16, v39
    v_and_b32 v59, s86, v39
    v_pk_add_f32 v[214:215], v[214:215], v[58:59]
    s_waitcnt vmcnt(1)
    v_lshlrev_b32 v56, 16, v40
    v_and_b32_e64 v57, s86, v40
    v_pk_add_f32 v[164:165], v[164:165], v[56:57]
    v_lshlrev_b32 v58, 16, v41
    v_and_b32 v59, s86, v41
    v_pk_add_f32 v[166:167], v[166:167], v[58:59]
    v_cvt_pk_bf16_f32 v80, v164, v165
    v_cvt_pk_bf16_f32 v81, v166, v167
    ds_write_b64 v8, v[80:81] offset:0
    v_lshlrev_b32 v56, 16, v42
    v_and_b32 v57, s86, v42
    v_pk_add_f32 v[180:181], v[180:181], v[56:57]
    v_lshlrev_b32 v58, 16, v43
    v_and_b32 v59, s86, v43
    v_pk_add_f32 v[182:183], v[182:183], v[58:59]
    v_cvt_pk_bf16_f32 v82, v180, v181
    v_cvt_pk_bf16_f32 v83, v182, v183
    ds_write_b64 v8, v[82:83] offset:32
    s_waitcnt vmcnt(0)
    v_lshlrev_b32 v56, 16, v44
    v_and_b32_e64 v57, s86, v44
    v_pk_add_f32 v[196:197], v[196:197], v[56:57]
    v_lshlrev_b32 v58, 16, v45
    v_and_b32 v59, s86, v45
    v_pk_add_f32 v[198:199], v[198:199], v[58:59]
    v_cvt_pk_bf16_f32 v84, v196, v197
    v_cvt_pk_bf16_f32 v85, v198, v199
    ds_write_b64 v8, v[84:85] offset:64
    v_lshlrev_b32 v56, 16, v46
    v_and_b32 v57, s86, v46
    v_pk_add_f32 v[212:213], v[212:213], v[56:57]
    v_lshlrev_b32 v58, 16, v47
    v_and_b32 v59, s86, v47
    v_pk_add_f32 v[214:215], v[214:215], v[58:59]
    v_cvt_pk_bf16_f32 v86, v212, v213
    v_cvt_pk_bf16_f32 v87, v214, v215
    ds_write_b64 v8, v[86:87] offset:96
    ds_read_b128 v[24:27], v9 offset:0
    ds_read_b128 v[28:31], v9 offset:1152
    s_waitcnt lgkmcnt(1)
    buffer_store_dwordx4 v[24:27], v10, s[44:47], s88 offen
    s_waitcnt lgkmcnt(0)
    buffer_store_dwordx4 v[28:31], v10, s[44:47], s89 offen
L_cdone:
L_end:
    s_endpgm
.section .rodata,"a"
.p2align 6
.amdhsa_kernel concat_heads__gqa_block_cached__mha_block_cached__near_ridge_kernel
  .amdhsa_next_free_vgpr 256
  .amdhsa_next_free_sgpr 102
  .amdhsa_accum_offset 256
  .amdhsa_group_segment_fixed_size 0
  .amdhsa_kernarg_size 104
  .amdhsa_user_sgpr_count 2
  .amdhsa_user_sgpr_kernarg_segment_ptr 1
  .amdhsa_system_sgpr_workgroup_id_x 1
.end_amdhsa_kernel
```
